```python
import torch

def _softmax(x, axis=-1):
    return torch.softmax(x, dim=axis)
def _gelu(x):
    return torch.nn.functional.gelu(x, approximate="tanh")
def _silu(x):
    return torch.nn.functional.silu(x)
def _sigmoid(x):
    return torch.sigmoid(x)
def _layernorm(x, axis=-1, eps=1e-5):
    m = x.mean(dim=axis, keepdim=True)
    v = x.var(dim=axis, keepdim=True, unbiased=False)
    return (x - m) / torch.sqrt(v + eps)
def _scatter_add(tgt, idx, src, axis=0):
    return tgt.clone().index_add_(axis, idx, src)
def _segment_sum(src, seg, n):
    out = torch.zeros((n,) + src.shape[1:], dtype=src.dtype)
    return out.index_add_(0, seg, src)
def _pad(x, pw):
    flat = tuple(v for pair in reversed(pw) for v in pair)
    return torch.nn.functional.pad(x, flat)

kernel_name = 'parallel_sum__ssm_conv_s4d__mixer_channel_mlp__prompt'

def setup_inputs():

    _w = (lambda a: (lambda t: t.to(torch.bfloat16) if t.is_floating_point() else t)(torch.as_tensor(a)))
    def _A_setup():
        Bsz, L, D, N = 1, 2048, 512, 128
        return {
            "u": _w((lambda *s: torch.randn(*s, dtype=torch.bfloat16) * 0.05)(Bsz, L, D)),
            "log_A_real": _w((lambda *s: torch.randn(*s, dtype=torch.bfloat16) * 3.2)(D, N) * 0.5),
            "A_imag": _w((lambda *s: torch.randn(*s, dtype=torch.bfloat16) * 0.05)(D, N) * 3.14),
            "C_real": _w((lambda *s: torch.randn(*s, dtype=torch.bfloat16) * 0.1)(D, N) / N ** 0.5),
            "C_imag": _w((lambda *s: torch.randn(*s, dtype=torch.bfloat16) * 0.2)(D, N) / N ** 0.5),
            "log_dt": _w((lambda *s: torch.randn(*s, dtype=torch.bfloat16) * 0.05)(D) * 0.5 - 4.0),
            "D_skip": _w((lambda *s: torch.randn(*s, dtype=torch.bfloat16) * 0.05)(D)),
        }
    _A_in = _A_setup()

    def _B_setup():
        B, S, D, F = 1, 2048, 512, 1376
        return {
            "x": _w((lambda *s: torch.randn(*s, dtype=torch.bfloat16) * 0.05)(B, S, D)),
            "w1": _w((lambda *s: torch.randn(*s, dtype=torch.bfloat16) * 1.6)(D, F) * (D ** -0.5)),
            "b1": _w((lambda *s: torch.randn(*s, dtype=torch.bfloat16) * 0.8)(F)),
            "w2": _w((lambda *s: torch.randn(*s, dtype=torch.bfloat16) * 0.05)(F, D) * (F ** -0.5)),
            "b2": _w((lambda *s: torch.randn(*s, dtype=torch.bfloat16) * 0.05)(D)),
        }
    _B_in = _B_setup()

    return {
        "A_u": _A_in["u"],
        "A_log_A_real": _A_in["log_A_real"],
        "A_A_imag": _A_in["A_imag"],
        "A_C_real": _A_in["C_real"],
        "A_C_imag": _A_in["C_imag"],
        "A_log_dt": _A_in["log_dt"],
        "A_D_skip": _A_in["D_skip"],
        "B_x": _B_in["x"],
        "B_w1": _B_in["w1"],
        "B_b1": _B_in["b1"],
        "B_w2": _B_in["w2"],
        "B_b2": _B_in["b2"],
    }

def reference(A_u, A_log_A_real, A_A_imag, A_C_real, A_C_imag, A_log_dt, A_D_skip, B_x, B_w1, B_b1, B_w2, B_b2):
    def _A_ref(u, log_A_real, A_imag, C_real, C_imag, log_dt, D_skip):
        L = u.shape[1]
        dt = torch.exp(log_dt)
        A = -torch.exp(log_A_real) + 1j * A_imag
        C = (C_real + 1j * C_imag) * dt[:, None]
        pos = (lambda x, dt: x.to(dt))(torch.arange(L), log_dt.dtype)
        P = torch.exp((A * dt[:, None])[:, :, None] * pos[None, None, :])
        K = 2.0 * torch.einsum("dn,dnl->dl", C, P).real
        L2 = 2 * L
        u_t = (lambda x, *d: x.permute(*d))(u, 0, 2, 1)
        Kf = (lambda x, *a, **k: torch.fft.rfft(x.float(), *a, **k))(K, L2)
        Uf = (lambda x, *a, **k: torch.fft.rfft(x.float(), *a, **k))(u_t, L2)
        y = (lambda x, *a, **k: torch.fft.irfft(x, *a, **k).to(torch.bfloat16))(Uf * Kf[None, :, :], L2)[:, :, :L]
        y = (lambda x, *d: x.permute(*d))(y, 0, 2, 1)
        return y + u * D_skip[None, None, :]

    def _B_ref(x, w1, b1, w2, b2):
        y = _layernorm(x, axis=-1)
        h = _gelu(torch.einsum("bsd,df->bsf", y, w1) + b1)
        return torch.einsum("bsf,fd->bsd", h, w2) + b2

    x = A_u
    xn = _layernorm(x, axis=-1)
    return x + _A_ref(xn, A_log_A_real, A_A_imag, A_C_real, A_C_imag, A_log_dt, A_D_skip) + _B_ref(xn, B_w1, B_b1, B_w2, B_b2)
```

```asm
; @launch grid=(512,1,1) block=(256,1,1) lds=81920
.amdgcn_target "amdgcn-amd-amdhsa--gfx950"
.text
.globl parallel_sum__ssm_conv_s4d__mixer_channel_mlp__prompt_kernel
.p2align 8
.type parallel_sum__ssm_conv_s4d__mixer_channel_mlp__prompt_kernel,@function
parallel_sum__ssm_conv_s4d__mixer_channel_mlp__prompt_kernel:
k_start:
    s_cmp_ge_u32 s2, 512
    s_cbranch_scc1 k_end
    s_cmp_ge_u32 s2, 256
    s_cbranch_scc1 k_g
    s_setprio 3
    s_load_dwordx2 s[4:5], s[0:1], 8
    s_load_dwordx2 s[6:7], s[0:1], 16
    s_load_dwordx2 s[8:9], s[0:1], 24
    s_load_dwordx2 s[12:13], s[0:1], 32
    s_load_dwordx2 s[14:15], s[0:1], 40
    s_load_dwordx2 s[16:17], s[0:1], 48
    s_load_dwordx2 s[10:11], s[0:1], 112
    s_load_dwordx2 s[18:19], s[0:1], 80
    s_load_dwordx2 s[92:93], s[0:1], 0
    s_load_dwordx2 s[94:95], s[0:1], 64
    s_load_dwordx2 s[34:35], s[0:1], 104
    s_memrealtime s[90:91]
    s_mov_b32 s33, s2
    v_and_b32 v1, 63, v0
    v_lshrrev_b32 v2, 6, v0
    s_nop 0
    v_readfirstlane_b32 s28, v2
    s_cmp_lg_u32 s28, 2
    s_cbranch_scc1 c_nocpf
    s_getpc_b64 s[60:61]
pc_1:
    s_sub_u32 s60, s60, pc_1-k_start
    s_subb_u32 s61, s61, 0
    v_lshlrev_b32 v240, 7, v1
    v_min_u32 v241, code_end-k_start-4, v240
    global_load_dword v242, v241, s[60:61]
    v_add_u32 v240, 0x2000, v240
    v_min_u32 v241, code_end-k_start-4, v240
    global_load_dword v243, v241, s[60:61]
    v_add_u32 v240, 0x2000, v240
    v_min_u32 v241, code_end-k_start-4, v240
    global_load_dword v244, v241, s[60:61]
    v_add_u32 v240, 0x2000, v240
    v_min_u32 v241, code_end-k_start-4, v240
    global_load_dword v245, v241, s[60:61]
c_nocpf:
    s_and_b32 s30, s33, 7
    s_lshr_b32 s31, s33, 3
    s_lshr_b32 s32, s31, 2
    s_lshl_b32 s32, s32, 3
    s_add_u32 s32, s32, s30
    s_lshl_b32 s32, s32, 2
    s_and_b32 s31, s31, 3
    s_add_u32 s32, s32, s31
    s_lshr_b32 s40, s28, 1
    s_and_b32 s41, s28, 1
    v_and_b32 v2, 127, v0
    v_lshlrev_b32 v3, 4, v1
    s_lshl_b32 s42, s32, 9
    s_lshl_b32 s43, s32, 2
    s_waitcnt lgkmcnt(0)
    s_mov_b32 s60, s34
    s_mov_b32 s61, s35
    s_mov_b32 s62, 0x100
    s_mov_b32 s63, 0x00020000
    v_mov_b32 v108, 0
    s_or_b32 s90, s90, 1
    s_add_u32 s30, s33, s28
    s_cmp_lg_u32 s30, 0
    s_cbranch_scc1 c_nowr
    v_mov_b32 v109, s90
    buffer_store_dword v109, v108, s[60:63], 0 offen sc1
c_nowr:
    s_load_dword s44, s[14:15], s43
    s_load_dword s45, s[16:17], s43
    s_cmp_eq_u32 s28, 1
    s_cselect_b32 s4, s6, s4
    s_cselect_b32 s5, s7, s5
    s_cmp_eq_u32 s28, 2
    s_cselect_b32 s4, s8, s4
    s_cselect_b32 s5, s9, s5
    s_cmp_eq_u32 s28, 3
    s_cselect_b32 s4, s12, s4
    s_cselect_b32 s5, s13, s5
    s_mov_b32 s20, s4
    s_mov_b32 s21, s5
    s_mov_b32 s22, 0x20000
    s_mov_b32 s23, 0x00020000
    s_lshl_b32 s46, s28, 9
    s_add_u32 m0, s46, 69632
    v_cmp_gt_u32 vcc, 32, v1
    s_and_saveexec_b64 s[46:47], vcc
    buffer_load_dwordx4 v3, s[20:23], s42 offen lds
    s_mov_b64 exec, s[46:47]
    s_mov_b32 s36, s10
    s_mov_b32 s37, s11
    s_mov_b32 s38, 0x1000000
    s_mov_b32 s39, 0x00020000
    s_mov_b32 s80, s18
    s_mov_b32 s81, s19
    s_mov_b32 s82, 0x158000
    s_mov_b32 s83, 0x00020000
    s_mov_b32 s72, s92
    s_mov_b32 s73, s93
    s_mov_b32 s74, 0x200000
    s_mov_b32 s75, 0x00020000
    s_mov_b32 s76, s94
    s_mov_b32 s77, s95
    s_mov_b32 s78, 0x158000
    s_mov_b32 s79, 0x00020000
    s_lshl_b32 s29, s33, 3
    s_lshl_b32 s30, s28, 1
    s_add_u32 s29, s29, s30
    s_lshl_b32 s30, s29, 10
    v_lshlrev_b32 v109, 4, v1
    buffer_load_dwordx4 v[128:131], v109, s[72:75], s30 offen
    s_add_u32 s30, s30, 1024
    buffer_load_dwordx4 v[132:135], v109, s[72:75], s30 offen
    s_mov_b32 s85, 0
    s_cmp_lg_u32 s28, 3
    s_cbranch_scc1 c_nocs
    s_cmp_ge_u32 s33, 172
    s_cbranch_scc1 c_nocs
    s_mov_b32 s85, 1
    v_lshrrev_b32 v110, 2, v1
    v_mul_u32_u24 v110, 2752, v110
    v_and_b32 v111, 3, v1
    v_lshl_add_u32 v110, v111, 4, v110
    s_lshr_b32 s30, s33, 2
    s_lshl_b32 s30, s30, 6
    s_and_b32 s31, s33, 3
    s_mul_i32 s31, s31, 352256
    s_add_u32 s30, s30, s31
    buffer_load_dwordx4 v[88:91], v110, s[76:79], s30 offen
    s_add_u32 s30, s30, 44032
    buffer_load_dwordx4 v[92:95], v110, s[76:79], s30 offen
    s_add_u32 s30, s30, 44032
    buffer_load_dwordx4 v[96:99], v110, s[76:79], s30 offen
    s_add_u32 s30, s30, 44032
    buffer_load_dwordx4 v[100:103], v110, s[76:79], s30 offen
    s_add_u32 s30, s30, 44032
    buffer_load_dwordx4 v[112:115], v110, s[76:79], s30 offen
    s_add_u32 s30, s30, 44032
    buffer_load_dwordx4 v[116:119], v110, s[76:79], s30 offen
    s_add_u32 s30, s30, 44032
    buffer_load_dwordx4 v[120:123], v110, s[76:79], s30 offen
    s_add_u32 s30, s30, 44032
    buffer_load_dwordx4 v[124:127], v110, s[76:79], s30 offen
    s_add_u32 s30, s30, 44032
c_nocs:
    s_mul_i32 s42, s40, 34816
    v_lshlrev_b32 v5, 2, v2
    v_add_u32 v5, s42, v5
    s_cmp_eq_u32 s85, 0
    s_cbranch_scc1 c_wa
    s_waitcnt vmcnt(10)
    s_branch c_wb
c_wa:
    s_waitcnt vmcnt(2)
c_wb:
    s_barrier
    s_cmp_lg_u32 s28, 0
    s_cbranch_scc1 c_non
    buffer_load_dword v109, v108, s[60:63], 0 offen sc1
c_non:
    v_lshlrev_b32 v3, 1, v2
    s_lshl_b32 s43, s40, 8
    v_add_u32 v3, s43, v3
    v_add_u32 v3, 69632, v3
    ds_read_u16 v8, v3
    ds_read_u16 v9, v3 offset:512
    ds_read_u16 v10, v3 offset:1024
    ds_read_u16 v11, v3 offset:1536
    s_waitcnt lgkmcnt(0)
    s_lshl_b32 s43, s40, 4
    s_lshr_b32 s44, s44, s43
    s_lshr_b32 s45, s45, s43
    v_mov_b32 v12, s44
    v_mov_b32 v13, s45
    v_lshlrev_b32 v8, 16, v8
    v_lshlrev_b32 v9, 16, v9
    v_lshlrev_b32 v10, 16, v10
    v_lshlrev_b32 v11, 16, v11
    v_lshlrev_b32 v12, 16, v12
    v_lshlrev_b32 v13, 16, v13
    v_mul_f32 v12, 0x3fb8aa3b, v12
    v_mul_f32 v8, 0x3fb8aa3b, v8
    v_exp_f32 v12, v12
    v_exp_f32 v8, v8
    s_nop 0
    v_cvt_pk_bf16_f32 v12, v12, v8
    v_and_b32 v8, 0xffff0000, v12
    v_lshlrev_b32 v12, 16, v12
    v_mul_f32 v8, v8, v12
    v_mul_f32 v8, 0xbfb8aa3b, v8
    v_mul_f32 v9, v9, v12
    v_mul_f32 v9, 0.15915494, v9
    v_add_f32 v12, v12, v12
    v_mul_f32 v10, v10, v12
    v_mul_f32 v11, v11, v12
    v_mul_f32 v14, 0x3f800000, v8
    v_mul_f32 v15, 0x3f800000, v9
    v_exp_f32 v14, v14
    v_fract_f32 v15, v15
    v_cos_f32 v34, v15
    v_sin_f32 v35, v15
    s_nop 0
    v_mul_f32 v34, v34, v14
    v_mul_f32 v35, v35, v14
    v_mul_f32 v14, 0x43800000, v8
    v_mul_f32 v15, 0x43800000, v9
    v_exp_f32 v14, v14
    v_fract_f32 v15, v15
    v_cos_f32 v24, v15
    v_sin_f32 v25, v15
    s_nop 0
    v_mul_f32 v24, v24, v14
    v_mul_f32 v25, v25, v14
    v_mul_f32 v14, 0x41800000, v8
    v_mul_f32 v15, 0x41800000, v9
    v_exp_f32 v14, v14
    v_fract_f32 v15, v15
    v_cos_f32 v22, v15
    v_sin_f32 v23, v15
    s_nop 0
    v_mul_f32 v22, v22, v14
    v_mul_f32 v23, v23, v14
    v_mov_b32 v32, 1.0
    v_mov_b32 v33, 0
    v_cvt_pk_bf16_f32 v20, v32, v33
    ds_write_b32 v5, v20 offset:8704
    v_cvt_pk_bf16_f32 v21, v34, v35
    ds_write_b32 v5, v21 offset:9248
    v_mul_f32 v17, v35, v35
    v_mul_f32 v18, v35, v34
    v_fma_f32 v37, v34, v35, v18
    v_fma_f32 v36, v34, v34, -v17
    v_cvt_pk_bf16_f32 v20, v36, v37
    ds_write_b32 v5, v20 offset:9792
    v_mul_f32 v19, v37, v35
    v_mul_f32 v26, v37, v34
    v_fma_f32 v39, v36, v35, v26
    v_fma_f32 v38, v36, v34, -v19
    v_cvt_pk_bf16_f32 v21, v38, v39
    ds_write_b32 v5, v21 offset:10336
    v_mul_f32 v27, v37, v37
    v_mul_f32 v28, v37, v36
    v_fma_f32 v41, v36, v37, v28
    v_fma_f32 v40, v36, v36, -v27
    v_cvt_pk_bf16_f32 v20, v40, v41
    ds_write_b32 v5, v20 offset:10880
    v_mul_f32 v29, v41, v35
    v_mul_f32 v30, v41, v34
    v_fma_f32 v43, v40, v35, v30
    v_fma_f32 v42, v40, v34, -v29
    v_cvt_pk_bf16_f32 v21, v42, v43
    ds_write_b32 v5, v21 offset:11424
    v_mul_f32 v17, v41, v37
    v_mul_f32 v18, v41, v36
    v_fma_f32 v45, v40, v37, v18
    v_fma_f32 v44, v40, v36, -v17
    v_cvt_pk_bf16_f32 v20, v44, v45
    ds_write_b32 v5, v20 offset:11968
    v_mul_f32 v19, v41, v39
    v_mul_f32 v26, v41, v38
    v_fma_f32 v47, v40, v39, v26
    v_fma_f32 v46, v40, v38, -v19
    v_cvt_pk_bf16_f32 v21, v46, v47
    ds_write_b32 v5, v21 offset:12512
    v_mul_f32 v27, v41, v41
    v_mul_f32 v28, v41, v40
    v_fma_f32 v49, v40, v41, v28
    v_fma_f32 v48, v40, v40, -v27
    v_cvt_pk_bf16_f32 v20, v48, v49
    ds_write_b32 v5, v20 offset:13056
    v_mul_f32 v29, v49, v35
    v_mul_f32 v30, v49, v34
    v_fma_f32 v51, v48, v35, v30
    v_fma_f32 v50, v48, v34, -v29
    v_cvt_pk_bf16_f32 v21, v50, v51
    ds_write_b32 v5, v21 offset:13600
    v_mul_f32 v17, v49, v37
    v_mul_f32 v18, v49, v36
    v_fma_f32 v53, v48, v37, v18
    v_fma_f32 v52, v48, v36, -v17
    v_cvt_pk_bf16_f32 v20, v52, v53
    ds_write_b32 v5, v20 offset:14144
    v_mul_f32 v19, v49, v39
    v_mul_f32 v26, v49, v38
    v_fma_f32 v55, v48, v39, v26
    v_fma_f32 v54, v48, v38, -v19
    v_cvt_pk_bf16_f32 v21, v54, v55
    ds_write_b32 v5, v21 offset:14688
    v_mul_f32 v27, v49, v41
    v_mul_f32 v28, v49, v40
    v_fma_f32 v57, v48, v41, v28
    v_fma_f32 v56, v48, v40, -v27
    v_cvt_pk_bf16_f32 v20, v56, v57
    ds_write_b32 v5, v20 offset:15232
    v_mul_f32 v29, v49, v43
    v_mul_f32 v30, v49, v42
    v_fma_f32 v59, v48, v43, v30
    v_fma_f32 v58, v48, v42, -v29
    v_cvt_pk_bf16_f32 v21, v58, v59
    ds_write_b32 v5, v21 offset:15776
    v_mul_f32 v17, v49, v45
    v_mul_f32 v18, v49, v44
    v_fma_f32 v61, v48, v45, v18
    v_fma_f32 v60, v48, v44, -v17
    v_cvt_pk_bf16_f32 v20, v60, v61
    ds_write_b32 v5, v20 offset:16320
    v_mul_f32 v19, v49, v47
    v_mul_f32 v26, v49, v46
    v_fma_f32 v63, v48, v47, v26
    v_fma_f32 v62, v48, v46, -v19
    v_cvt_pk_bf16_f32 v21, v62, v63
    ds_write_b32 v5, v21 offset:16864
    v_mul_f32 v17, v23, v23
    v_mul_f32 v18, v23, v22
    v_fma_f32 v65, v22, v23, v18
    v_fma_f32 v64, v22, v22, -v17
    v_mov_b32 v66, v10
    v_mov_b32 v67, v11
    v_mul_f32 v19, v11, v23
    v_mul_f32 v26, v11, v22
    v_fma_f32 v69, v10, v23, v26
    v_fma_f32 v68, v10, v22, -v19
    v_cvt_pk_bf16_f32 v27, v66, -v67
    ds_write_b32 v5, v27 offset:0
    v_cvt_pk_bf16_f32 v28, v68, -v69
    ds_write_b32 v5, v28 offset:544
    v_mul_f32 v17, v67, v65
    v_mul_f32 v18, v67, v64
    v_fma_f32 v67, v66, v65, v18
    v_fma_f32 v66, v66, v64, -v17
    v_mul_f32 v19, v69, v65
    v_mul_f32 v26, v69, v64
    v_fma_f32 v69, v68, v65, v26
    v_fma_f32 v68, v68, v64, -v19
    v_cvt_pk_bf16_f32 v27, v66, -v67
    ds_write_b32 v5, v27 offset:1088
    v_cvt_pk_bf16_f32 v28, v68, -v69
    ds_write_b32 v5, v28 offset:1632
    v_mul_f32 v17, v67, v65
    v_mul_f32 v18, v67, v64
    v_fma_f32 v67, v66, v65, v18
    v_fma_f32 v66, v66, v64, -v17
    v_mul_f32 v19, v69, v65
    v_mul_f32 v26, v69, v64
    v_fma_f32 v69, v68, v65, v26
    v_fma_f32 v68, v68, v64, -v19
    v_cvt_pk_bf16_f32 v27, v66, -v67
    ds_write_b32 v5, v27 offset:2176
    v_cvt_pk_bf16_f32 v28, v68, -v69
    ds_write_b32 v5, v28 offset:2720
    v_mul_f32 v17, v67, v65
    v_mul_f32 v18, v67, v64
    v_fma_f32 v67, v66, v65, v18
    v_fma_f32 v66, v66, v64, -v17
    v_mul_f32 v19, v69, v65
    v_mul_f32 v26, v69, v64
    v_fma_f32 v69, v68, v65, v26
    v_fma_f32 v68, v68, v64, -v19
    v_cvt_pk_bf16_f32 v27, v66, -v67
    ds_write_b32 v5, v27 offset:3264
    v_cvt_pk_bf16_f32 v28, v68, -v69
    ds_write_b32 v5, v28 offset:3808
    v_mul_f32 v17, v67, v65
    v_mul_f32 v18, v67, v64
    v_fma_f32 v67, v66, v65, v18
    v_fma_f32 v66, v66, v64, -v17
    v_mul_f32 v19, v69, v65
    v_mul_f32 v26, v69, v64
    v_fma_f32 v69, v68, v65, v26
    v_fma_f32 v68, v68, v64, -v19
    v_cvt_pk_bf16_f32 v27, v66, -v67
    ds_write_b32 v5, v27 offset:4352
    v_cvt_pk_bf16_f32 v28, v68, -v69
    ds_write_b32 v5, v28 offset:4896
    v_mul_f32 v17, v67, v65
    v_mul_f32 v18, v67, v64
    v_fma_f32 v67, v66, v65, v18
    v_fma_f32 v66, v66, v64, -v17
    v_mul_f32 v19, v69, v65
    v_mul_f32 v26, v69, v64
    v_fma_f32 v69, v68, v65, v26
    v_fma_f32 v68, v68, v64, -v19
    v_cvt_pk_bf16_f32 v27, v66, -v67
    ds_write_b32 v5, v27 offset:5440
    v_cvt_pk_bf16_f32 v28, v68, -v69
    ds_write_b32 v5, v28 offset:5984
    v_mul_f32 v17, v67, v65
    v_mul_f32 v18, v67, v64
    v_fma_f32 v67, v66, v65, v18
    v_fma_f32 v66, v66, v64, -v17
    v_mul_f32 v19, v69, v65
    v_mul_f32 v26, v69, v64
    v_fma_f32 v69, v68, v65, v26
    v_fma_f32 v68, v68, v64, -v19
    v_cvt_pk_bf16_f32 v27, v66, -v67
    ds_write_b32 v5, v27 offset:6528
    v_cvt_pk_bf16_f32 v28, v68, -v69
    ds_write_b32 v5, v28 offset:7072
    v_mul_f32 v17, v67, v65
    v_mul_f32 v18, v67, v64
    v_fma_f32 v67, v66, v65, v18
    v_fma_f32 v66, v66, v64, -v17
    v_mul_f32 v19, v69, v65
    v_mul_f32 v26, v69, v64
    v_fma_f32 v69, v68, v65, v26
    v_fma_f32 v68, v68, v64, -v19
    v_cvt_pk_bf16_f32 v27, v66, -v67
    ds_write_b32 v5, v27 offset:7616
    v_cvt_pk_bf16_f32 v28, v68, -v69
    ds_write_b32 v5, v28 offset:8160
    v_cvt_pk_bf16_f32 v27, v24, v25
    ds_write_b32 v5, v27 offset:17408
    v_mul_f32 v19, v25, v37
    v_mul_f32 v26, v25, v36
    v_fma_f32 v71, v24, v37, v26
    v_fma_f32 v70, v24, v36, -v19
    v_cvt_pk_bf16_f32 v28, v70, v71
    ds_write_b32 v5, v28 offset:17952
    v_mul_f32 v17, v25, v41
    v_mul_f32 v18, v25, v40
    v_fma_f32 v73, v24, v41, v18
    v_fma_f32 v72, v24, v40, -v17
    v_cvt_pk_bf16_f32 v27, v72, v73
    ds_write_b32 v5, v27 offset:18496
    v_mul_f32 v19, v25, v45
    v_mul_f32 v26, v25, v44
    v_fma_f32 v71, v24, v45, v26
    v_fma_f32 v70, v24, v44, -v19
    v_cvt_pk_bf16_f32 v28, v70, v71
    ds_write_b32 v5, v28 offset:19040
    v_mul_f32 v17, v25, v49
    v_mul_f32 v18, v25, v48
    v_fma_f32 v73, v24, v49, v18
    v_fma_f32 v72, v24, v48, -v17
    v_cvt_pk_bf16_f32 v27, v72, v73
    ds_write_b32 v5, v27 offset:19584
    v_mul_f32 v19, v25, v53
    v_mul_f32 v26, v25, v52
    v_fma_f32 v71, v24, v53, v26
    v_fma_f32 v70, v24, v52, -v19
    v_cvt_pk_bf16_f32 v28, v70, v71
    ds_write_b32 v5, v28 offset:20128
    v_mul_f32 v17, v25, v57
    v_mul_f32 v18, v25, v56
    v_fma_f32 v73, v24, v57, v18
    v_fma_f32 v72, v24, v56, -v17
    v_cvt_pk_bf16_f32 v27, v72, v73
    ds_write_b32 v5, v27 offset:20672
    v_mul_f32 v19, v25, v61
    v_mul_f32 v26, v25, v60
    v_fma_f32 v71, v24, v61, v26
    v_fma_f32 v70, v24, v60, -v19
    v_cvt_pk_bf16_f32 v28, v70, v71
    ds_write_b32 v5, v28 offset:21216
    v_mul_f32 v17, v25, v25
    v_mul_f32 v18, v25, v24
    v_fma_f32 v75, v24, v25, v18
    v_fma_f32 v74, v24, v24, -v17
    v_mul_f32 v19, v75, v25
    v_mul_f32 v26, v75, v24
    v_fma_f32 v77, v74, v25, v26
    v_fma_f32 v76, v74, v24, -v19
    v_mul_f32 v17, v75, v75
    v_mul_f32 v18, v75, v74
    v_fma_f32 v79, v74, v75, v18
    v_fma_f32 v78, v74, v74, -v17
    v_mul_f32 v19, v79, v25
    v_mul_f32 v26, v79, v24
    v_fma_f32 v81, v78, v25, v26
    v_fma_f32 v80, v78, v24, -v19
    v_mul_f32 v17, v79, v75
    v_mul_f32 v18, v79, v74
    v_fma_f32 v83, v78, v75, v18
    v_fma_f32 v82, v78, v74, -v17
    v_mul_f32 v19, v79, v77
    v_mul_f32 v26, v79, v76
    v_fma_f32 v85, v78, v77, v26
    v_fma_f32 v84, v78, v76, -v19
    v_mul_f32 v17, v79, v79
    v_mul_f32 v18, v79, v78
    v_fma_f32 v87, v78, v79, v18
    v_fma_f32 v86, v78, v78, -v17
    v_cvt_pk_bf16_f32 v27, v74, v75
    ds_write_b32 v5, v27 offset:21760
    v_mul_f32 v19, v75, v41
    v_mul_f32 v26, v75, v40
    v_fma_f32 v71, v74, v41, v26
    v_fma_f32 v70, v74, v40, -v19
    v_cvt_pk_bf16_f32 v28, v70, v71
    ds_write_b32 v5, v28 offset:22304
    v_mul_f32 v17, v75, v49
    v_mul_f32 v18, v75, v48
    v_fma_f32 v73, v74, v49, v18
    v_fma_f32 v72, v74, v48, -v17
    v_cvt_pk_bf16_f32 v27, v72, v73
    ds_write_b32 v5, v27 offset:22848
    v_mul_f32 v19, v75, v57
    v_mul_f32 v26, v75, v56
    v_fma_f32 v71, v74, v57, v26
    v_fma_f32 v70, v74, v56, -v19
    v_cvt_pk_bf16_f32 v28, v70, v71
    ds_write_b32 v5, v28 offset:23392
    v_cvt_pk_bf16_f32 v27, v76, v77
    ds_write_b32 v5, v27 offset:23936
    v_mul_f32 v19, v77, v41
    v_mul_f32 v26, v77, v40
    v_fma_f32 v71, v76, v41, v26
    v_fma_f32 v70, v76, v40, -v19
    v_cvt_pk_bf16_f32 v28, v70, v71
    ds_write_b32 v5, v28 offset:24480
    v_mul_f32 v17, v77, v49
    v_mul_f32 v18, v77, v48
    v_fma_f32 v73, v76, v49, v18
    v_fma_f32 v72, v76, v48, -v17
    v_cvt_pk_bf16_f32 v27, v72, v73
    ds_write_b32 v5, v27 offset:25024
    v_mul_f32 v19, v77, v57
    v_mul_f32 v26, v77, v56
    v_fma_f32 v71, v76, v57, v26
    v_fma_f32 v70, v76, v56, -v19
    v_cvt_pk_bf16_f32 v28, v70, v71
    ds_write_b32 v5, v28 offset:25568
    v_cvt_pk_bf16_f32 v27, v78, v79
    ds_write_b32 v5, v27 offset:26112
    v_mul_f32 v17, v79, v49
    v_mul_f32 v18, v79, v48
    v_fma_f32 v73, v78, v49, v18
    v_fma_f32 v72, v78, v48, -v17
    v_cvt_pk_bf16_f32 v28, v72, v73
    ds_write_b32 v5, v28 offset:26656
    v_cvt_pk_bf16_f32 v27, v80, v81
    ds_write_b32 v5, v27 offset:27200
    v_mul_f32 v19, v81, v49
    v_mul_f32 v26, v81, v48
    v_fma_f32 v71, v80, v49, v26
    v_fma_f32 v70, v80, v48, -v19
    v_cvt_pk_bf16_f32 v28, v70, v71
    ds_write_b32 v5, v28 offset:27744
    v_cvt_pk_bf16_f32 v27, v82, v83
    ds_write_b32 v5, v27 offset:28288
    v_mul_f32 v17, v83, v49
    v_mul_f32 v18, v83, v48
    v_fma_f32 v73, v82, v49, v18
    v_fma_f32 v72, v82, v48, -v17
    v_cvt_pk_bf16_f32 v28, v72, v73
    ds_write_b32 v5, v28 offset:28832
    v_cvt_pk_bf16_f32 v27, v84, v85
    ds_write_b32 v5, v27 offset:29376
    v_mul_f32 v19, v85, v49
    v_mul_f32 v26, v85, v48
    v_fma_f32 v71, v84, v49, v26
    v_fma_f32 v70, v84, v48, -v19
    v_cvt_pk_bf16_f32 v28, v70, v71
    ds_write_b32 v5, v28 offset:29920
    v_cvt_pk_bf16_f32 v27, v86, v87
    ds_write_b32 v5, v27 offset:30464
    s_cmp_eq_u32 s85, 0
    s_cbranch_scc1 c_lw0
    s_waitcnt vmcnt(8)
    s_branch c_lw1
c_lw0:
    s_cmp_eq_u32 s28, 0
    s_cbranch_scc1 c_lw2
    s_waitcnt vmcnt(0)
    s_branch c_lw1
c_lw2:
    s_waitcnt vmcnt(1)
c_lw1:
    v_lshlrev_b32 v32, 16, v128
    v_and_b32 v33, 0xffff0000, v128
    v_lshlrev_b32 v34, 16, v129
    v_and_b32 v35, 0xffff0000, v129
    v_lshlrev_b32 v36, 16, v130
    v_and_b32 v37, 0xffff0000, v130
    v_lshlrev_b32 v38, 16, v131
    v_and_b32 v39, 0xffff0000, v131
    v_lshlrev_b32 v40, 16, v132
    v_and_b32 v41, 0xffff0000, v132
    v_lshlrev_b32 v42, 16, v133
    v_and_b32 v43, 0xffff0000, v133
    v_lshlrev_b32 v44, 16, v134
    v_and_b32 v45, 0xffff0000, v134
    v_lshlrev_b32 v46, 16, v135
    v_and_b32 v47, 0xffff0000, v135
    v_add_f32 v48, v32, v33
    v_mul_f32 v49, v32, v32
    v_add_f32 v50, v40, v41
    v_mul_f32 v51, v40, v40
    v_fmac_f32 v49, v33, v33
    v_fmac_f32 v51, v41, v41
    v_add_f32 v48, v48, v34
    v_fmac_f32 v49, v34, v34
    v_add_f32 v50, v50, v42
    v_fmac_f32 v51, v42, v42
    v_add_f32 v48, v48, v35
    v_fmac_f32 v49, v35, v35
    v_add_f32 v50, v50, v43
    v_fmac_f32 v51, v43, v43
    v_add_f32 v48, v48, v36
    v_fmac_f32 v49, v36, v36
    v_add_f32 v50, v50, v44
    v_fmac_f32 v51, v44, v44
    v_add_f32 v48, v48, v37
    v_fmac_f32 v49, v37, v37
    v_add_f32 v50, v50, v45
    v_fmac_f32 v51, v45, v45
    v_add_f32 v48, v48, v38
    v_fmac_f32 v49, v38, v38
    v_add_f32 v50, v50, v46
    v_fmac_f32 v51, v46, v46
    v_add_f32 v48, v48, v39
    v_fmac_f32 v49, v39, v39
    v_add_f32 v50, v50, v47
    v_fmac_f32 v51, v47, v47
    v_add_f32_dpp v48, v48, v48 quad_perm:[1,0,3,2] row_mask:0xf bank_mask:0xf
    v_add_f32_dpp v49, v49, v49 quad_perm:[1,0,3,2] row_mask:0xf bank_mask:0xf
    v_add_f32_dpp v50, v50, v50 quad_perm:[1,0,3,2] row_mask:0xf bank_mask:0xf
    v_add_f32_dpp v51, v51, v51 quad_perm:[1,0,3,2] row_mask:0xf bank_mask:0xf
    v_add_f32_dpp v48, v48, v48 quad_perm:[2,3,0,1] row_mask:0xf bank_mask:0xf
    v_add_f32_dpp v49, v49, v49 quad_perm:[2,3,0,1] row_mask:0xf bank_mask:0xf
    v_add_f32_dpp v50, v50, v50 quad_perm:[2,3,0,1] row_mask:0xf bank_mask:0xf
    v_add_f32_dpp v51, v51, v51 quad_perm:[2,3,0,1] row_mask:0xf bank_mask:0xf
    v_add_f32_dpp v48, v48, v48 row_half_mirror row_mask:0xf bank_mask:0xf
    v_add_f32_dpp v49, v49, v49 row_half_mirror row_mask:0xf bank_mask:0xf
    v_add_f32_dpp v50, v50, v50 row_half_mirror row_mask:0xf bank_mask:0xf
    v_add_f32_dpp v51, v51, v51 row_half_mirror row_mask:0xf bank_mask:0xf
    v_add_f32_dpp v48, v48, v48 row_mirror row_mask:0xf bank_mask:0xf
    v_add_f32_dpp v49, v49, v49 row_mirror row_mask:0xf bank_mask:0xf
    v_add_f32_dpp v50, v50, v50 row_mirror row_mask:0xf bank_mask:0xf
    v_add_f32_dpp v51, v51, v51 row_mirror row_mask:0xf bank_mask:0xf
    v_mov_b32 v52, v48
    v_mov_b32 v53, v49
    v_mov_b32 v54, v50
    v_mov_b32 v55, v51
    v_permlane16_swap_b32 v48, v52
    v_permlane16_swap_b32 v49, v53
    v_permlane16_swap_b32 v50, v54
    v_permlane16_swap_b32 v51, v55
    v_add_f32 v48, v48, v52
    v_add_f32 v49, v49, v53
    v_add_f32 v50, v50, v54
    v_add_f32 v51, v51, v55
    v_mov_b32 v52, v48
    v_mov_b32 v53, v49
    v_mov_b32 v54, v50
    v_mov_b32 v55, v51
    v_permlane32_swap_b32 v48, v52
    v_permlane32_swap_b32 v49, v53
    v_permlane32_swap_b32 v50, v54
    v_permlane32_swap_b32 v51, v55
    v_add_f32 v48, v48, v52
    v_add_f32 v49, v49, v53
    v_add_f32 v50, v50, v54
    v_add_f32 v51, v51, v55
    v_mul_f32 v56, 0x3b000000, v48
    v_mul_f32 v57, 0x3b000000, v49
    v_fma_f32 v57, -v56, v56, v57
    v_max_f32 v57, 0, v57
    v_add_f32 v57, 0x3727c5ac, v57
    v_rsq_f32 v57, v57
    v_mul_f32 v58, 0x3b000000, v50
    v_mul_f32 v59, 0x3b000000, v51
    v_fma_f32 v59, -v58, v58, v59
    v_max_f32 v59, 0, v59
    v_add_f32 v59, 0x3727c5ac, v59
    v_rsq_f32 v59, v59
    v_mul_f32 v56, v56, v57
    v_mul_f32 v58, v58, v59
    v_fma_f32 v32, v32, v57, -v56
    v_fma_f32 v33, v33, v57, -v56
    v_fma_f32 v34, v34, v57, -v56
    v_fma_f32 v35, v35, v57, -v56
    v_fma_f32 v36, v36, v57, -v56
    v_fma_f32 v37, v37, v57, -v56
    v_fma_f32 v38, v38, v57, -v56
    v_fma_f32 v39, v39, v57, -v56
    v_cvt_pk_bf16_f32 v146, v32, v33
    v_cvt_pk_bf16_f32 v147, v34, v35
    v_cvt_pk_bf16_f32 v148, v36, v37
    v_cvt_pk_bf16_f32 v149, v38, v39
    v_fma_f32 v40, v40, v59, -v58
    v_fma_f32 v41, v41, v59, -v58
    v_fma_f32 v42, v42, v59, -v58
    v_fma_f32 v43, v43, v59, -v58
    v_fma_f32 v44, v44, v59, -v58
    v_fma_f32 v45, v45, v59, -v58
    v_fma_f32 v46, v46, v59, -v58
    v_fma_f32 v47, v47, v59, -v58
    v_cvt_pk_bf16_f32 v150, v40, v41
    v_cvt_pk_bf16_f32 v151, v42, v43
    v_cvt_pk_bf16_f32 v152, v44, v45
    v_cvt_pk_bf16_f32 v153, v46, v47
    s_lshl_b32 s30, s28, 1
    s_mul_i32 s30, s30, 1040
    s_add_u32 s30, s30, 72448
    v_lshlrev_b32 v60, 4, v1
    v_add_u32 v60, s30, v60
    ds_write_b128 v60, v[146:149]
    ds_write_b128 v60, v[150:153] offset:1040
    v_cmp_eq_u32 vcc, 1, v1
    s_nop 1
    v_cndmask_b32 v40, v48, v50, vcc
    v_cndmask_b32 v41, v49, v51, vcc
    v_mul_f32 v40, 0x3b000000, v40
    v_mul_f32 v41, 0x3b000000, v41
    v_fma_f32 v41, -v40, v40, v41
    v_max_f32 v41, 0, v41
    v_add_f32 v42, 0x3727c5ac, v41
    v_rsq_f32 v43, v42
    v_sub_f32 v44, 0, v40
    v_mul_f32 v42, v42, v43
    v_mul_f32 v45, v41, v43
    v_mul_f32 v45, v45, v43
    v_add_f32 v45, 0x3727c5ac, v45
    v_rsq_f32 v46, v45
    v_mul_f32 v142, v44, v43
    v_mul_f32 v45, v45, v46
    v_mul_f32 v140, v43, v46
    v_mul_f32 v42, v42, v45
    v_mov_b32 v141, v43
    v_cvt_pk_bf16_f32 v45, v44, v42
    v_lshlrev_b32 v46, 16, v45
    v_and_b32 v47, 0xffff0000, v45
    v_sub_f32 v46, v44, v46
    v_sub_f32 v47, v42, v47
    v_cvt_pk_bf16_f32 v46, v46, v47
    s_mov_b32 s30, 0x05040100
    v_perm_b32 v136, v46, v45, s30
    v_mov_b32 v137, v45
    v_lshrrev_b32 v138, 16, v46
    s_cmp_lg_u32 s28, 0
    s_cbranch_scc1 c_npx
    s_mov_b32 s31, 0
    s_waitcnt vmcnt(0)
c_np:
    v_readfirstlane_b32 s86, v109
    s_cmp_lg_u32 s86, 0
    s_cbranch_scc1 c_npok
    s_add_u32 s31, s31, 1
    s_cmp_gt_u32 s31, 20000
    s_cbranch_scc1 c_npok
    buffer_load_dword v109, v108, s[60:63], 0 offen sc1
    s_waitcnt vmcnt(0)
    s_branch c_np
c_npok:
    v_mov_b32 v44, 80800
    v_mov_b32 v45, s86
    ds_write_b32 v44, v45
c_npx:
    s_waitcnt lgkmcnt(0)
    s_barrier
    v_mov_b32 v44, 80800
    ds_read_b32 v45, v44
    s_waitcnt lgkmcnt(0)
    v_readfirstlane_b32 s86, v45
    v_add_u32 v44, s29, v1
    v_lshlrev_b32 v44, 5, v44
    v_add_u32 v44, 14680064, v44
    v_mov_b32 v139, s86
    v_mov_b32 v143, s86
    v_cmp_gt_u32 vcc, 2, v1
    s_and_saveexec_b64 s[88:89], vcc
    buffer_store_dwordx4 v[136:139], v44, s[36:39], 0 offen sc1
    buffer_store_dwordx4 v[140:143], v44, s[36:39], 0 offen offset:16 sc1
    s_mov_b64 exec, s[88:89]
    v_lshlrev_b32 v60, 1, v0
    v_add_u32 v60, 72448, v60
    ds_read_u16 v32, v60 offset:0
    ds_read_u16 v33, v60 offset:1040
    ds_read_u16 v34, v60 offset:2080
    ds_read_u16 v35, v60 offset:3120
    ds_read_u16 v36, v60 offset:4160
    ds_read_u16 v37, v60 offset:5200
    ds_read_u16 v38, v60 offset:6240
    ds_read_u16 v39, v60 offset:7280
    v_lshlrev_b32 v61, 1, v0
    v_add_u32 v61, 72960, v61
    ds_read_u16 v40, v61 offset:0
    ds_read_u16 v41, v61 offset:1040
    ds_read_u16 v42, v61 offset:2080
    ds_read_u16 v43, v61 offset:3120
    ds_read_u16 v44, v61 offset:4160
    ds_read_u16 v45, v61 offset:5200
    ds_read_u16 v46, v61 offset:6240
    ds_read_u16 v47, v61 offset:7280
    v_lshlrev_b32 v62, 4, v0
    s_lshl_b32 s30, s33, 13
    s_add_u32 s30, s30, 6291456
    s_add_u32 s31, s30, 4096
    s_waitcnt lgkmcnt(0)
    v_lshl_or_b32 v48, v33, 16, v32
    v_lshl_or_b32 v49, v35, 16, v34
    v_lshl_or_b32 v50, v37, 16, v36
    v_lshl_or_b32 v51, v39, 16, v38
    buffer_store_dwordx4 v[48:51], v62, s[36:39], s30 offen sc1
    v_lshl_or_b32 v52, v41, 16, v40
    v_lshl_or_b32 v53, v43, 16, v42
    v_lshl_or_b32 v54, v45, 16, v44
    v_lshl_or_b32 v55, v47, 16, v46
    buffer_store_dwordx4 v[52:55], v62, s[36:39], s31 offen sc1
    s_cmp_eq_u32 s85, 0
    s_cbranch_scc1 c_csd
    s_waitcnt vmcnt(4)
    v_and_b32 v44, 15, v1
    v_mov_b32 v45, 0x3f80
    v_mov_b32 v46, 0x3f800000
    v_cmp_eq_u32 vcc, 0, v44
    v_cmp_eq_u32 s[88:89], 1, v44
    s_nop 0
    v_cndmask_b32 v48, 0, v45, vcc
    v_cndmask_b32 v48, v48, v46, s[88:89]
    v_cmp_eq_u32 vcc, 2, v44
    v_cmp_eq_u32 s[88:89], 3, v44
    s_nop 0
    v_cndmask_b32 v49, 0, v45, vcc
    v_cndmask_b32 v49, v49, v46, s[88:89]
    v_cmp_eq_u32 vcc, 4, v44
    v_cmp_eq_u32 s[88:89], 5, v44
    s_nop 0
    v_cndmask_b32 v50, 0, v45, vcc
    v_cndmask_b32 v50, v50, v46, s[88:89]
    v_cmp_eq_u32 vcc, 6, v44
    v_cmp_eq_u32 s[88:89], 7, v44
    s_nop 0
    v_cndmask_b32 v51, 0, v45, vcc
    v_cndmask_b32 v51, v51, v46, s[88:89]
    v_mov_b32 v52, 0
    v_mov_b32 v53, 0
    v_mov_b32 v54, 0
    v_mov_b32 v55, 0
    s_nop 1
    v_mfma_f32_16x16x32_bf16 v[52:55], v[88:91], v[48:51], v[52:55]
    v_mfma_f32_16x16x32_bf16 v[52:55], v[92:95], v[48:51], v[52:55]
    v_mfma_f32_16x16x32_bf16 v[52:55], v[96:99], v[48:51], v[52:55]
    v_mfma_f32_16x16x32_bf16 v[52:55], v[100:103], v[48:51], v[52:55]
    v_mfma_f32_16x16x32_bf16 v[52:55], v[112:115], v[48:51], v[52:55]
    v_mfma_f32_16x16x32_bf16 v[52:55], v[116:119], v[48:51], v[52:55]
    v_mfma_f32_16x16x32_bf16 v[52:55], v[120:123], v[48:51], v[52:55]
    v_mfma_f32_16x16x32_bf16 v[52:55], v[124:127], v[48:51], v[52:55]
    s_nop 7
    v_mov_b32 v56, v52
    v_mov_b32 v57, v53
    v_mov_b32 v58, v54
    v_mov_b32 v59, v55
    s_nop 0
    v_permlane16_swap_b32 v52, v56
    v_permlane16_swap_b32 v53, v57
    v_permlane16_swap_b32 v54, v58
    v_permlane16_swap_b32 v55, v59
    v_add_f32 v52, v52, v56
    v_add_f32 v53, v53, v57
    v_add_f32 v54, v54, v58
    v_add_f32 v55, v55, v59
    v_mov_b32 v56, v52
    v_mov_b32 v57, v53
    v_mov_b32 v58, v54
    v_mov_b32 v59, v55
    s_nop 0
    v_permlane32_swap_b32 v52, v56
    v_permlane32_swap_b32 v53, v57
    v_permlane32_swap_b32 v54, v58
    v_permlane32_swap_b32 v55, v59
    v_add_f32 v52, v52, v56
    v_add_f32 v53, v53, v57
    v_add_f32 v54, v54, v58
    v_add_f32 v55, v55, v59
    v_mov_b32 v56, v52
    v_mov_b32 v57, s86
    v_mov_b32 v58, v53
    v_mov_b32 v59, s86
    v_mov_b32 v60, v54
    v_mov_b32 v61, s86
    v_mov_b32 v62, v55
    v_mov_b32 v63, s86
    s_lshl_b32 s30, s33, 8
    s_add_u32 s30, s30, 14745600
    v_lshlrev_b32 v44, 3, v1
    v_cmp_gt_u32 vcc, 8, v1
    s_and_saveexec_b64 s[88:89], vcc
    buffer_store_dwordx2 v[56:57], v44, s[36:39], s30 offen offset:0 sc1
    buffer_store_dwordx2 v[58:59], v44, s[36:39], s30 offen offset:64 sc1
    buffer_store_dwordx2 v[60:61], v44, s[36:39], s30 offen offset:128 sc1
    buffer_store_dwordx2 v[62:63], v44, s[36:39], s30 offen offset:192 sc1
    s_mov_b64 exec, s[88:89]
c_csd:
    s_setprio 1
    s_waitcnt lgkmcnt(0)
    s_waitcnt vmcnt(0)
    s_barrier
    s_cmp_lg_u32 s28, 0
    s_cbranch_scc1 c_noua
    s_lshl_b32 s30, s33, 7
    s_add_u32 s30, s30, 15073280
    v_mov_b32 v6, s86
    v_mov_b32 v7, 0
    s_mov_b64 s[46:47], exec
    s_mov_b64 exec, 1
    buffer_store_dword v6, v7, s[36:39], s30 offen sc1
    s_mov_b64 exec, s[46:47]
c_noua:
    s_mov_b32 s51, s28
    s_cmp_ge_u32 s51, 3
    s_cselect_b32 s48, 1, 0
    s_mul_i32 s49, s48, 3
    s_sub_u32 s49, s51, s49
    v_and_b32 v2, 15, v1
    v_lshrrev_b32 v3, 4, v1
    v_mul_u32_u24 v4, 544, v2
    v_lshl_add_u32 v4, v3, 4, v4
    s_mul_i32 s42, s48, 34816
    v_add_u32 v4, s42, v4
    s_mul_i32 s42, s49, 8704
    s_add_u32 s42, s42, 8704
    v_add_u32 v7, s42, v4
    ds_read_b128 v[32:35], v4 offset:0
    ds_read_b128 v[36:39], v4 offset:64
    ds_read_b128 v[40:43], v4 offset:128
    ds_read_b128 v[44:47], v4 offset:192
    ds_read_b128 v[48:51], v4 offset:256
    ds_read_b128 v[52:55], v4 offset:320
    ds_read_b128 v[56:59], v4 offset:384
    ds_read_b128 v[60:63], v4 offset:448
    ds_read_b128 v[64:67], v7 offset:0
    ds_read_b128 v[68:71], v7 offset:64
    ds_read_b128 v[72:75], v7 offset:128
    ds_read_b128 v[76:79], v7 offset:192
    ds_read_b128 v[80:83], v7 offset:256
    ds_read_b128 v[84:87], v7 offset:320
    ds_read_b128 v[88:91], v7 offset:384
    ds_read_b128 v[92:95], v7 offset:448
    v_mov_b32 v100, 0
    v_mov_b32 v101, 0
    v_mov_b32 v102, 0
    v_mov_b32 v103, 0
    v_mov_b32 v6, v2
    v_mov_b32 v7, 16
    s_cmp_eq_u32 s49, 0
    s_cbranch_scc1 c_ixa
    s_cmp_eq_u32 s49, 1
    s_cbranch_scc0 c_ix2a
    v_add_u32 v6, 256, v2
    v_bfe_u32 v8, v2, 2, 1
    v_lshlrev_b32 v8, 6, v8
    v_and_b32 v9, 3, v2
    v_add_u32 v8, v8, v9
    v_add_u32 v8, 384, v8
    v_cmp_gt_u32 vcc, 8, v2
    s_nop 1
    v_cndmask_b32 v6, v8, v6, vcc
    v_cndmask_b32 v7, 4, 8, vcc
    s_branch c_ixa
c_ix2a:
    v_lshrrev_b32 v6, 1, v2
    v_lshlrev_b32 v6, 5, v6
    v_and_b32 v9, 1, v2
    v_add_u32 v6, v6, v9
    v_add_u32 v6, 512, v6
    v_add_u32 v8, 632, v2
    v_cmp_gt_u32 vcc, 8, v2
    s_nop 1
    v_cndmask_b32 v6, v8, v6, vcc
    v_cndmask_b32 v7, 1, 2, vcc
c_ixa:
    v_lshlrev_b32 v8, 2, v3
    v_mul_u32_u24 v8, v8, v7
    v_add_u32 v6, v6, v8
    v_lshlrev_b32 v6, 1, v6
    v_lshlrev_b32 v7, 1, v7
    s_mul_i32 s50, s48, 1344
    s_add_u32 s50, s50, 69632
    v_add_u32 v6, s50, v6
    s_waitcnt lgkmcnt(0)
    v_mfma_f32_16x16x32_bf16 v[100:103], v[32:35], v[64:67], v[100:103]
    v_mfma_f32_16x16x32_bf16 v[100:103], v[36:39], v[68:71], v[100:103]
    v_mfma_f32_16x16x32_bf16 v[100:103], v[40:43], v[72:75], v[100:103]
    v_mfma_f32_16x16x32_bf16 v[100:103], v[44:47], v[76:79], v[100:103]
    v_mfma_f32_16x16x32_bf16 v[100:103], v[48:51], v[80:83], v[100:103]
    v_mfma_f32_16x16x32_bf16 v[100:103], v[52:55], v[84:87], v[100:103]
    v_mfma_f32_16x16x32_bf16 v[100:103], v[56:59], v[88:91], v[100:103]
    v_mfma_f32_16x16x32_bf16 v[100:103], v[60:63], v[92:95], v[100:103]
    s_nop 1
    v_cmp_eq_u32 vcc, 0, v1
    s_cmp_eq_u32 s49, 0
    s_cselect_b64 s[46:47], vcc, 0
    s_nop 3
    v_cndmask_b32 v8, 0, v13, s[46:47]
    v_add_f32 v100, v100, v8
    v_cvt_pk_bf16_f32 v9, v100, v100
    ds_write_b16 v6, v9
    v_add_u32 v6, v6, v7
    v_cvt_pk_bf16_f32 v9, v101, v101
    ds_write_b16 v6, v9
    v_add_u32 v6, v6, v7
    v_cvt_pk_bf16_f32 v9, v102, v102
    ds_write_b16 v6, v9
    v_add_u32 v6, v6, v7
    v_cvt_pk_bf16_f32 v9, v103, v103
    ds_write_b16 v6, v9
    s_cmp_ge_u32 s28, 2
    s_cbranch_scc1 c_tdone
    s_add_u32 s51, s28, 4
    s_cmp_ge_u32 s51, 3
    s_cselect_b32 s48, 1, 0
    s_mul_i32 s49, s48, 3
    s_sub_u32 s49, s51, s49
    v_and_b32 v2, 15, v1
    v_lshrrev_b32 v3, 4, v1
    v_mul_u32_u24 v4, 544, v2
    v_lshl_add_u32 v4, v3, 4, v4
    s_mul_i32 s42, s48, 34816
    v_add_u32 v4, s42, v4
    s_mul_i32 s42, s49, 8704
    s_add_u32 s42, s42, 8704
    v_add_u32 v7, s42, v4
    ds_read_b128 v[32:35], v4 offset:0
    ds_read_b128 v[36:39], v4 offset:64
    ds_read_b128 v[40:43], v4 offset:128
    ds_read_b128 v[44:47], v4 offset:192
    ds_read_b128 v[48:51], v4 offset:256
    ds_read_b128 v[52:55], v4 offset:320
    ds_read_b128 v[56:59], v4 offset:384
    ds_read_b128 v[60:63], v4 offset:448
    ds_read_b128 v[64:67], v7 offset:0
    ds_read_b128 v[68:71], v7 offset:64
    ds_read_b128 v[72:75], v7 offset:128
    ds_read_b128 v[76:79], v7 offset:192
    ds_read_b128 v[80:83], v7 offset:256
    ds_read_b128 v[84:87], v7 offset:320
    ds_read_b128 v[88:91], v7 offset:384
    ds_read_b128 v[92:95], v7 offset:448
    v_mov_b32 v100, 0
    v_mov_b32 v101, 0
    v_mov_b32 v102, 0
    v_mov_b32 v103, 0
    v_mov_b32 v6, v2
    v_mov_b32 v7, 16
    s_cmp_eq_u32 s49, 0
    s_cbranch_scc1 c_ixb
    s_cmp_eq_u32 s49, 1
    s_cbranch_scc0 c_ix2b
    v_add_u32 v6, 256, v2
    v_bfe_u32 v8, v2, 2, 1
    v_lshlrev_b32 v8, 6, v8
    v_and_b32 v9, 3, v2
    v_add_u32 v8, v8, v9
    v_add_u32 v8, 384, v8
    v_cmp_gt_u32 vcc, 8, v2
    s_nop 1
    v_cndmask_b32 v6, v8, v6, vcc
    v_cndmask_b32 v7, 4, 8, vcc
    s_branch c_ixb
c_ix2b:
    v_lshrrev_b32 v6, 1, v2
    v_lshlrev_b32 v6, 5, v6
    v_and_b32 v9, 1, v2
    v_add_u32 v6, v6, v9
    v_add_u32 v6, 512, v6
    v_add_u32 v8, 632, v2
    v_cmp_gt_u32 vcc, 8, v2
    s_nop 1
    v_cndmask_b32 v6, v8, v6, vcc
    v_cndmask_b32 v7, 1, 2, vcc
c_ixb:
    v_lshlrev_b32 v8, 2, v3
    v_mul_u32_u24 v8, v8, v7
    v_add_u32 v6, v6, v8
    v_lshlrev_b32 v6, 1, v6
    v_lshlrev_b32 v7, 1, v7
    s_mul_i32 s50, s48, 1344
    s_add_u32 s50, s50, 69632
    v_add_u32 v6, s50, v6
    s_waitcnt lgkmcnt(0)
    v_mfma_f32_16x16x32_bf16 v[100:103], v[32:35], v[64:67], v[100:103]
    v_mfma_f32_16x16x32_bf16 v[100:103], v[36:39], v[68:71], v[100:103]
    v_mfma_f32_16x16x32_bf16 v[100:103], v[40:43], v[72:75], v[100:103]
    v_mfma_f32_16x16x32_bf16 v[100:103], v[44:47], v[76:79], v[100:103]
    v_mfma_f32_16x16x32_bf16 v[100:103], v[48:51], v[80:83], v[100:103]
    v_mfma_f32_16x16x32_bf16 v[100:103], v[52:55], v[84:87], v[100:103]
    v_mfma_f32_16x16x32_bf16 v[100:103], v[56:59], v[88:91], v[100:103]
    v_mfma_f32_16x16x32_bf16 v[100:103], v[60:63], v[92:95], v[100:103]
    s_nop 1
    v_cmp_eq_u32 vcc, 0, v1
    s_cmp_eq_u32 s49, 0
    s_cselect_b64 s[46:47], vcc, 0
    s_nop 3
    v_cndmask_b32 v8, 0, v13, s[46:47]
    v_add_f32 v100, v100, v8
    v_cvt_pk_bf16_f32 v9, v100, v100
    ds_write_b16 v6, v9
    v_add_u32 v6, v6, v7
    v_cvt_pk_bf16_f32 v9, v101, v101
    ds_write_b16 v6, v9
    v_add_u32 v6, v6, v7
    v_cvt_pk_bf16_f32 v9, v102, v102
    ds_write_b16 v6, v9
    v_add_u32 v6, v6, v7
    v_cvt_pk_bf16_f32 v9, v103, v103
    ds_write_b16 v6, v9
c_tdone:
    s_lshl_b32 s52, s28, 13
    s_add_u32 s52, s52, 15073280
    v_lshlrev_b32 v158, 7, v1
    buffer_load_dword v159, v158, s[36:39], s52 offen sc1
    s_waitcnt lgkmcnt(0)
    s_barrier
    v_lshlrev_b32 v2, 3, v0
    v_sub_u32 v2, 2040, v2
    v_or_b32 v3, 1, v2
    v_ffbh_u32 v3, v3
    v_sub_u32 v3, 24, v3
    v_max_i32 v3, 0, v3
    v_lshlrev_b32 v4, v3, 1
    v_lshrrev_b32 v4, 1, v4
    v_min_u32 v6, 1, v3
    v_sub_u32 v4, v4, v6
    v_lshlrev_b32 v7, 8, v3
    v_add_u32 v7, 69632, v7
    v_add_u32 v8, 7, v2
    v_lshrrev_b32 v9, v3, v8
    v_and_b32 v9, v9, v6
    v_add3_u32 v8, v8, v4, v9
    v_lshrrev_b32 v8, v3, v8
    v_lshl_add_u32 v8, v8, 1, v7
    ds_read_u16 v48, v8
    ds_read_u16 v56, v8 offset:1344
    v_add_u32 v8, 6, v2
    v_lshrrev_b32 v9, v3, v8
    v_and_b32 v9, v9, v6
    v_add3_u32 v8, v8, v4, v9
    v_lshrrev_b32 v8, v3, v8
    v_lshl_add_u32 v8, v8, 1, v7
    ds_read_u16 v49, v8
    ds_read_u16 v57, v8 offset:1344
    v_add_u32 v8, 5, v2
    v_lshrrev_b32 v9, v3, v8
    v_and_b32 v9, v9, v6
    v_add3_u32 v8, v8, v4, v9
    v_lshrrev_b32 v8, v3, v8
    v_lshl_add_u32 v8, v8, 1, v7
    ds_read_u16 v50, v8
    ds_read_u16 v58, v8 offset:1344
    v_add_u32 v8, 4, v2
    v_lshrrev_b32 v9, v3, v8
    v_and_b32 v9, v9, v6
    v_add3_u32 v8, v8, v4, v9
    v_lshrrev_b32 v8, v3, v8
    v_lshl_add_u32 v8, v8, 1, v7
    ds_read_u16 v51, v8
    ds_read_u16 v59, v8 offset:1344
    v_add_u32 v8, 3, v2
    v_lshrrev_b32 v9, v3, v8
    v_and_b32 v9, v9, v6
    v_add3_u32 v8, v8, v4, v9
    v_lshrrev_b32 v8, v3, v8
    v_lshl_add_u32 v8, v8, 1, v7
    ds_read_u16 v52, v8
    ds_read_u16 v60, v8 offset:1344
    v_add_u32 v8, 2, v2
    v_lshrrev_b32 v9, v3, v8
    v_and_b32 v9, v9, v6
    v_add3_u32 v8, v8, v4, v9
    v_lshrrev_b32 v8, v3, v8
    v_lshl_add_u32 v8, v8, 1, v7
    ds_read_u16 v53, v8
    ds_read_u16 v61, v8 offset:1344
    v_add_u32 v8, 1, v2
    v_lshrrev_b32 v9, v3, v8
    v_and_b32 v9, v9, v6
    v_add3_u32 v8, v8, v4, v9
    v_lshrrev_b32 v8, v3, v8
    v_lshl_add_u32 v8, v8, 1, v7
    ds_read_u16 v54, v8
    ds_read_u16 v62, v8 offset:1344
    v_add_u32 v8, 0, v2
    v_lshrrev_b32 v9, v3, v8
    v_and_b32 v9, v9, v6
    v_add3_u32 v8, v8, v4, v9
    v_lshrrev_b32 v8, v3, v8
    v_lshl_add_u32 v8, v8, 1, v7
    ds_read_u16 v55, v8
    ds_read_u16 v63, v8 offset:1344
    v_lshlrev_b32 v2, 4, v0
    v_add_u32 v37, 33280, v2
    v_mov_b32 v40, 0
    v_mov_b32 v41, 0
    v_mov_b32 v42, 0
    v_mov_b32 v43, 0
    s_waitcnt lgkmcnt(0)
    v_lshl_or_b32 v32, v49, 16, v48
    v_lshl_or_b32 v33, v51, 16, v50
    v_lshl_or_b32 v34, v53, 16, v52
    v_lshl_or_b32 v35, v55, 16, v54
    v_lshl_or_b32 v64, v57, 16, v56
    v_lshl_or_b32 v65, v59, 16, v58
    v_lshl_or_b32 v66, v61, 16, v60
    v_lshl_or_b32 v67, v63, 16, v62
    ds_write_b128 v2, v[32:35]
    ds_write_b128 v37, v[64:67]
    v_and_b32 v3, 3, v0
    v_lshlrev_b32 v3, 4, v3
    v_add_u32 v3, 4096, v3
    v_bfe_u32 v4, v0, 2, 1
    v_mul_u32_u24 v38, 33280, v4
    v_add_u32 v38, v38, v3
    v_cmp_gt_u32 vcc, 8, v0
    s_and_saveexec_b64 s[46:47], vcc
    ds_write_b128 v38, v[40:43]
    ds_write_b128 v38, v[40:43] offset:64
    s_mov_b64 exec, s[46:47]
    s_waitcnt vmcnt(0)
    v_cmp_ne_u32 vcc, s86, v159
    s_cmp_eq_u64 vcc, 0
    s_cbranch_scc1 c_ufast
    s_mov_b32 s98, 0
c_uf:
    s_mov_b32 exec_lo, 0xffffffff
    s_mov_b32 exec_hi, 0xffffffff
    buffer_load_dword v159, v158, s[36:39], s52 offen sc1
    s_mov_b64 exec, -1
    s_waitcnt vmcnt(0)
    v_cmp_ne_u32 vcc, s86, v159
    s_mov_b32 s96, 0xffffffff
    s_mov_b32 s97, 0xffffffff
    s_and_b64 vcc, vcc, s[96:97]
    s_cmp_eq_u64 vcc, 0
    s_cbranch_scc1 c_ufok
    s_add_u32 s98, s98, 1
    s_cmp_gt_u32 s98, 20000
    s_cbranch_scc1 c_ufok
    s_sleep 8
    s_branch c_uf
c_ufok:
c_ufast:
    s_waitcnt lgkmcnt(0)
    s_barrier
    s_lshl_b32 s44, s32, 5
    s_add_u32 s44, s44, 6291456
    v_lshlrev_b32 v168, 13, v0
    buffer_load_dwordx4 v[160:163], v168, s[36:39], s44 offen sc1
    buffer_load_dwordx4 v[164:167], v168, s[36:39], s44 offen offset:16 sc1
    ds_read_b128 v[8:11], v2
    ds_read_b128 v[12:15], v2 offset:16
    ds_read_b128 v[16:19], v37
    ds_read_b128 v[20:23], v37 offset:16
    ds_read_b128 v[24:27], v38
    ds_read_b128 v[28:31], v38 offset:16
    s_waitcnt lgkmcnt(4)
    v_mov_b32 v40, v9
    v_mov_b32 v41, v10
    v_mov_b32 v42, v11
    v_mov_b32 v43, v12
    v_mov_b32 v44, v13
    v_mov_b32 v45, v14
    v_alignbit_b32 v48, v9, v8, 16
    v_alignbit_b32 v49, v10, v9, 16
    v_alignbit_b32 v50, v11, v10, 16
    v_alignbit_b32 v51, v12, v11, 16
    v_alignbit_b32 v52, v13, v12, 16
    v_alignbit_b32 v53, v14, v13, 16
    v_alignbit_b32 v56, v10, v9, 16
    v_alignbit_b32 v57, v11, v10, 16
    v_alignbit_b32 v58, v12, v11, 16
    v_alignbit_b32 v59, v13, v12, 16
    v_alignbit_b32 v60, v14, v13, 16
    v_alignbit_b32 v61, v15, v14, 16
    ds_write_b128 v2, v[10:13] offset:16640
    ds_write_b128 v2, v[40:43] offset:8320
    ds_write_b128 v2, v[42:45] offset:24960
    ds_write_b128 v2, v[48:51] offset:4160
    ds_write_b128 v2, v[50:53] offset:20800
    ds_write_b128 v2, v[56:59] offset:12480
    ds_write_b128 v2, v[58:61] offset:29120
    s_waitcnt lgkmcnt(9)
    v_mov_b32 v40, v17
    v_mov_b32 v41, v18
    v_mov_b32 v42, v19
    v_mov_b32 v43, v20
    v_mov_b32 v44, v21
    v_mov_b32 v45, v22
    v_alignbit_b32 v48, v17, v16, 16
    v_alignbit_b32 v49, v18, v17, 16
    v_alignbit_b32 v50, v19, v18, 16
    v_alignbit_b32 v51, v20, v19, 16
    v_alignbit_b32 v52, v21, v20, 16
    v_alignbit_b32 v53, v22, v21, 16
    v_alignbit_b32 v56, v18, v17, 16
    v_alignbit_b32 v57, v19, v18, 16
    v_alignbit_b32 v58, v20, v19, 16
    v_alignbit_b32 v59, v21, v20, 16
    v_alignbit_b32 v60, v22, v21, 16
    v_alignbit_b32 v61, v23, v22, 16
    ds_write_b128 v37, v[18:21] offset:16640
    ds_write_b128 v37, v[40:43] offset:8320
    ds_write_b128 v37, v[42:45] offset:24960
    ds_write_b128 v37, v[48:51] offset:4160
    ds_write_b128 v37, v[50:53] offset:20800
    ds_write_b128 v37, v[56:59] offset:12480
    ds_write_b128 v37, v[58:61] offset:29120
    v_cmp_gt_u32 vcc, 8, v0
    s_and_saveexec_b64 s[46:47], vcc
    s_cbranch_execz c2_noex
    s_waitcnt lgkmcnt(0)
    v_mov_b32 v40, v25
    v_mov_b32 v41, v26
    v_mov_b32 v42, v27
    v_mov_b32 v43, v28
    v_mov_b32 v44, v29
    v_mov_b32 v45, v30
    v_alignbit_b32 v48, v25, v24, 16
    v_alignbit_b32 v49, v26, v25, 16
    v_alignbit_b32 v50, v27, v26, 16
    v_alignbit_b32 v51, v28, v27, 16
    v_alignbit_b32 v52, v29, v28, 16
    v_alignbit_b32 v53, v30, v29, 16
    v_alignbit_b32 v56, v26, v25, 16
    v_alignbit_b32 v57, v27, v26, 16
    v_alignbit_b32 v58, v28, v27, 16
    v_alignbit_b32 v59, v29, v28, 16
    v_alignbit_b32 v60, v30, v29, 16
    v_alignbit_b32 v61, v31, v30, 16
    ds_write_b128 v38, v[26:29] offset:16640
    ds_write_b128 v38, v[40:43] offset:8320
    ds_write_b128 v38, v[42:45] offset:24960
    ds_write_b128 v38, v[48:51] offset:4160
    ds_write_b128 v38, v[50:53] offset:20800
    ds_write_b128 v38, v[56:59] offset:12480
    ds_write_b128 v38, v[58:61] offset:29120
c2_noex:
    s_mov_b64 exec, s[46:47]
    v_mov_b32 v32, 0
    v_mov_b32 v33, 0
    v_mov_b32 v34, 0
    v_mov_b32 v35, 0
    v_lshrrev_b32 v7, 4, v0
    v_mul_u32_u24 v7, 1280, v7
    v_and_b32 v36, 15, v0
    v_lshl_add_u32 v7, v36, 4, v7
    v_add_u32 v7, 66560, v7
    v_cmp_gt_u32 vcc, 128, v0
    s_and_saveexec_b64 s[46:47], vcc
    ds_write_b128 v7, v[32:35]
    s_mov_b64 exec, s[46:47]
    v_and_b32 v4, 3, v0
    v_mul_u32_u24 v4, 1280, v4
    v_lshrrev_b32 v5, 2, v0
    v_lshl_add_u32 v3, v5, 4, v4
    v_add_u32 v3, 66816, v3
    s_waitcnt vmcnt(0)
    ds_write_b128 v3, v[160:163]
    ds_write_b128 v3, v[164:167] offset:5120
    s_waitcnt lgkmcnt(0)
    s_barrier
    s_setprio 2
    v_and_b32 v2, 3, v1
    v_sub_u32 v2, 7, v2
    v_mul_u32_u24 v2, 4160, v2
    v_bfe_u32 v3, v1, 2, 2
    v_lshrrev_b32 v4, 4, v1
    v_sub_u32 v3, v4, v3
    v_lshlrev_b32 v3, 4, v3
    v_add_u32 v2, v2, v3
    s_mul_i32 s42, s40, 33280
    s_add_u32 s42, s42, 4080
    v_add_u32 v8, s42, v2
    v_subrev_u32 v9, 16640, v8
    v_mul_u32_u24 v2, 1280, v4
    v_and_b32 v3, 15, v1
    v_lshl_add_u32 v2, v3, 4, v2
    s_mul_i32 s42, s40, 5120
    s_add_u32 s42, s42, 66816
    v_add_u32 v10, s42, v2
    v_mov_b32 v16, 0
    v_mov_b32 v17, 0
    v_mov_b32 v18, 0
    v_mov_b32 v19, 0
    v_mov_b32 v20, 0
    v_mov_b32 v21, 0
    v_mov_b32 v22, 0
    v_mov_b32 v23, 0
    v_mov_b32 v24, 0
    v_mov_b32 v25, 0
    v_mov_b32 v26, 0
    v_mov_b32 v27, 0
    v_mov_b32 v28, 0
    v_mov_b32 v29, 0
    v_mov_b32 v30, 0
    v_mov_b32 v31, 0
    v_mov_b32 v32, 0
    v_mov_b32 v33, 0
    v_mov_b32 v34, 0
    v_mov_b32 v35, 0
    v_mov_b32 v36, 0
    v_mov_b32 v37, 0
    v_mov_b32 v38, 0
    v_mov_b32 v39, 0
    v_mov_b32 v40, 0
    v_mov_b32 v41, 0
    v_mov_b32 v42, 0
    v_mov_b32 v43, 0
    v_mov_b32 v44, 0
    v_mov_b32 v45, 0
    v_mov_b32 v46, 0
    v_mov_b32 v47, 0
    s_cmp_eq_u32 s41, 0
    s_cbranch_scc0 c2_p1
    v_subrev_u32 v11, 0, v8
    v_subrev_u32 v12, 0, v9
    v_subrev_u32 v13, 0, v10
    ds_read_b128 v[48:51], v11 offset:0
    ds_read_b128 v[52:55], v12 offset:0
    ds_read_b128 v[56:59], v13 offset:0
    ds_read_b128 v[60:63], v13 offset:256
    ds_read_b128 v[64:67], v13 offset:512
    ds_read_b128 v[68:71], v13 offset:768
    v_subrev_u32 v11, 64, v11
    v_subrev_u32 v12, 64, v12
    v_subrev_u32 v13, 16, v13
    s_mov_b32 s48, 8
c2_a0:
    s_waitcnt lgkmcnt(0)
    v_mfma_f32_16x16x32_bf16 v[16:19], v[48:51], v[56:59], v[16:19]
    ds_read_b128 v[72:75], v11 offset:0
    ds_read_b128 v[76:79], v12 offset:0
    v_mfma_f32_16x16x32_bf16 v[20:23], v[52:55], v[56:59], v[20:23]
    ds_read_b128 v[80:83], v13 offset:0
    ds_read_b128 v[84:87], v13 offset:256
    v_mfma_f32_16x16x32_bf16 v[24:27], v[48:51], v[60:63], v[24:27]
    ds_read_b128 v[88:91], v13 offset:512
    ds_read_b128 v[92:95], v13 offset:768
    v_mfma_f32_16x16x32_bf16 v[28:31], v[52:55], v[60:63], v[28:31]
    v_subrev_u32 v11, 64, v11
    v_subrev_u32 v12, 64, v12
    v_mfma_f32_16x16x32_bf16 v[32:35], v[48:51], v[64:67], v[32:35]
    v_subrev_u32 v13, 16, v13
    v_mfma_f32_16x16x32_bf16 v[36:39], v[52:55], v[64:67], v[36:39]
    v_mfma_f32_16x16x32_bf16 v[40:43], v[48:51], v[68:71], v[40:43]
    v_mfma_f32_16x16x32_bf16 v[44:47], v[52:55], v[68:71], v[44:47]
    s_waitcnt lgkmcnt(0)
    v_mfma_f32_16x16x32_bf16 v[16:19], v[72:75], v[80:83], v[16:19]
    ds_read_b128 v[48:51], v11 offset:0
    ds_read_b128 v[52:55], v12 offset:0
    v_mfma_f32_16x16x32_bf16 v[20:23], v[76:79], v[80:83], v[20:23]
    ds_read_b128 v[56:59], v13 offset:0
    ds_read_b128 v[60:63], v13 offset:256
    v_mfma_f32_16x16x32_bf16 v[24:27], v[72:75], v[84:87], v[24:27]
    ds_read_b128 v[64:67], v13 offset:512
    ds_read_b128 v[68:71], v13 offset:768
    v_mfma_f32_16x16x32_bf16 v[28:31], v[76:79], v[84:87], v[28:31]
    v_subrev_u32 v11, 64, v11
    v_subrev_u32 v12, 64, v12
    v_mfma_f32_16x16x32_bf16 v[32:35], v[72:75], v[88:91], v[32:35]
    v_subrev_u32 v13, 16, v13
    v_mfma_f32_16x16x32_bf16 v[36:39], v[76:79], v[88:91], v[36:39]
    v_mfma_f32_16x16x32_bf16 v[40:43], v[72:75], v[92:95], v[40:43]
    v_mfma_f32_16x16x32_bf16 v[44:47], v[76:79], v[92:95], v[44:47]
    s_sub_u32 s48, s48, 1
    s_cmp_lg_u32 s48, 0
    s_cbranch_scc1 c2_a0
    s_waitcnt lgkmcnt(0)
    v_subrev_u32 v11, 3264, v8
    v_subrev_u32 v12, 3264, v9
    v_subrev_u32 v13, 816, v10
    ds_read_b128 v[48:51], v11 offset:192
    ds_read_b128 v[52:55], v12 offset:192
    ds_read_b128 v[56:59], v13 offset:816
    ds_read_b128 v[60:63], v11 offset:128
    ds_read_b128 v[64:67], v12 offset:128
    ds_read_b128 v[68:71], v13 offset:800
    ds_read_b128 v[72:75], v11 offset:64
    ds_read_b128 v[76:79], v12 offset:64
    ds_read_b128 v[80:83], v13 offset:784
    ds_read_b128 v[84:87], v11 offset:0
    ds_read_b128 v[88:91], v12 offset:0
    ds_read_b128 v[92:95], v13 offset:768
    v_subrev_u32 v11, 256, v11
    v_subrev_u32 v12, 256, v12
    v_subrev_u32 v13, 64, v13
    s_mov_b32 s48, 2
c2_a1:
    s_waitcnt lgkmcnt(0)
    v_mfma_f32_16x16x32_bf16 v[40:43], v[48:51], v[56:59], v[40:43]
    ds_read_b128 v[96:99], v11 offset:192
    ds_read_b128 v[100:103], v12 offset:192
    v_mfma_f32_16x16x32_bf16 v[44:47], v[52:55], v[56:59], v[44:47]
    ds_read_b128 v[104:107], v13 offset:816
    ds_read_b128 v[108:111], v11 offset:128
    v_mfma_f32_16x16x32_bf16 v[40:43], v[60:63], v[68:71], v[40:43]
    ds_read_b128 v[112:115], v12 offset:128
    ds_read_b128 v[116:119], v13 offset:800
    v_mfma_f32_16x16x32_bf16 v[44:47], v[64:67], v[68:71], v[44:47]
    ds_read_b128 v[120:123], v11 offset:64
    ds_read_b128 v[124:127], v12 offset:64
    v_mfma_f32_16x16x32_bf16 v[40:43], v[72:75], v[80:83], v[40:43]
    ds_read_b128 v[128:131], v13 offset:784
    ds_read_b128 v[132:135], v11 offset:0
    v_mfma_f32_16x16x32_bf16 v[44:47], v[76:79], v[80:83], v[44:47]
    ds_read_b128 v[136:139], v12 offset:0
    ds_read_b128 v[140:143], v13 offset:768
    v_mfma_f32_16x16x32_bf16 v[40:43], v[84:87], v[92:95], v[40:43]
    v_subrev_u32 v11, 256, v11
    v_subrev_u32 v12, 256, v12
    v_mfma_f32_16x16x32_bf16 v[44:47], v[88:91], v[92:95], v[44:47]
    v_subrev_u32 v13, 64, v13
    s_waitcnt lgkmcnt(0)
    v_mfma_f32_16x16x32_bf16 v[40:43], v[96:99], v[104:107], v[40:43]
    ds_read_b128 v[48:51], v11 offset:192
    ds_read_b128 v[52:55], v12 offset:192
    v_mfma_f32_16x16x32_bf16 v[44:47], v[100:103], v[104:107], v[44:47]
    ds_read_b128 v[56:59], v13 offset:816
    ds_read_b128 v[60:63], v11 offset:128
    v_mfma_f32_16x16x32_bf16 v[40:43], v[108:111], v[116:119], v[40:43]
    ds_read_b128 v[64:67], v12 offset:128
    ds_read_b128 v[68:71], v13 offset:800
    v_mfma_f32_16x16x32_bf16 v[44:47], v[112:115], v[116:119], v[44:47]
    ds_read_b128 v[72:75], v11 offset:64
    ds_read_b128 v[76:79], v12 offset:64
    v_mfma_f32_16x16x32_bf16 v[40:43], v[120:123], v[128:131], v[40:43]
    ds_read_b128 v[80:83], v13 offset:784
    ds_read_b128 v[84:87], v11 offset:0
    v_mfma_f32_16x16x32_bf16 v[44:47], v[124:127], v[128:131], v[44:47]
    ds_read_b128 v[88:91], v12 offset:0
    ds_read_b128 v[92:95], v13 offset:768
    v_mfma_f32_16x16x32_bf16 v[40:43], v[132:135], v[140:143], v[40:43]
    v_subrev_u32 v11, 256, v11
    v_subrev_u32 v12, 256, v12
    v_mfma_f32_16x16x32_bf16 v[44:47], v[136:139], v[140:143], v[44:47]
    v_subrev_u32 v13, 64, v13
    s_sub_u32 s48, s48, 1
    s_cmp_lg_u32 s48, 0
    s_cbranch_scc1 c2_a1
    s_waitcnt lgkmcnt(0)
    s_branch c2_pd
c2_p1:
    v_subrev_u32 v11, 1024, v8
    v_subrev_u32 v12, 1024, v9
    v_subrev_u32 v13, 256, v10
    ds_read_b128 v[48:51], v11 offset:0
    ds_read_b128 v[52:55], v12 offset:0
    ds_read_b128 v[56:59], v13 offset:256
    ds_read_b128 v[60:63], v13 offset:512
    ds_read_b128 v[64:67], v13 offset:768
    v_subrev_u32 v11, 64, v11
    v_subrev_u32 v12, 64, v12
    v_subrev_u32 v13, 16, v13
    s_mov_b32 s48, 8
c2_b0:
    s_waitcnt lgkmcnt(0)
    v_mfma_f32_16x16x32_bf16 v[24:27], v[48:51], v[56:59], v[24:27]
    ds_read_b128 v[68:71], v11 offset:0
    ds_read_b128 v[72:75], v12 offset:0
    v_mfma_f32_16x16x32_bf16 v[28:31], v[52:55], v[56:59], v[28:31]
    ds_read_b128 v[76:79], v13 offset:256
    ds_read_b128 v[80:83], v13 offset:512
    v_mfma_f32_16x16x32_bf16 v[32:35], v[48:51], v[60:63], v[32:35]
    ds_read_b128 v[84:87], v13 offset:768
    v_subrev_u32 v11, 64, v11
    v_mfma_f32_16x16x32_bf16 v[36:39], v[52:55], v[60:63], v[36:39]
    v_subrev_u32 v12, 64, v12
    v_subrev_u32 v13, 16, v13
    v_mfma_f32_16x16x32_bf16 v[40:43], v[48:51], v[64:67], v[40:43]
    v_mfma_f32_16x16x32_bf16 v[44:47], v[52:55], v[64:67], v[44:47]
    s_waitcnt lgkmcnt(0)
    v_mfma_f32_16x16x32_bf16 v[24:27], v[68:71], v[76:79], v[24:27]
    ds_read_b128 v[48:51], v11 offset:0
    ds_read_b128 v[52:55], v12 offset:0
    v_mfma_f32_16x16x32_bf16 v[28:31], v[72:75], v[76:79], v[28:31]
    ds_read_b128 v[56:59], v13 offset:256
    ds_read_b128 v[60:63], v13 offset:512
    v_mfma_f32_16x16x32_bf16 v[32:35], v[68:71], v[80:83], v[32:35]
    ds_read_b128 v[64:67], v13 offset:768
    v_subrev_u32 v11, 64, v11
    v_mfma_f32_16x16x32_bf16 v[36:39], v[72:75], v[80:83], v[36:39]
    v_subrev_u32 v12, 64, v12
    v_subrev_u32 v13, 16, v13
    v_mfma_f32_16x16x32_bf16 v[40:43], v[68:71], v[84:87], v[40:43]
    v_mfma_f32_16x16x32_bf16 v[44:47], v[72:75], v[84:87], v[44:47]
    s_sub_u32 s48, s48, 1
    s_cmp_lg_u32 s48, 0
    s_cbranch_scc1 c2_b0
    s_waitcnt lgkmcnt(0)
    v_subrev_u32 v11, 2112, v8
    v_subrev_u32 v12, 2112, v9
    v_subrev_u32 v13, 528, v10
    ds_read_b128 v[48:51], v11 offset:64
    ds_read_b128 v[52:55], v12 offset:64
    ds_read_b128 v[56:59], v13 offset:528
    ds_read_b128 v[60:63], v13 offset:784
    ds_read_b128 v[64:67], v11 offset:0
    ds_read_b128 v[68:71], v12 offset:0
    ds_read_b128 v[72:75], v13 offset:512
    ds_read_b128 v[76:79], v13 offset:768
    v_subrev_u32 v11, 128, v11
    v_subrev_u32 v12, 128, v12
    v_subrev_u32 v13, 32, v13
    s_mov_b32 s48, 4
c2_b1:
    s_waitcnt lgkmcnt(0)
    v_mfma_f32_16x16x32_bf16 v[32:35], v[48:51], v[56:59], v[32:35]
    ds_read_b128 v[80:83], v11 offset:64
    ds_read_b128 v[84:87], v12 offset:64
    v_mfma_f32_16x16x32_bf16 v[36:39], v[52:55], v[56:59], v[36:39]
    ds_read_b128 v[88:91], v13 offset:528
    ds_read_b128 v[92:95], v13 offset:784
    v_mfma_f32_16x16x32_bf16 v[40:43], v[48:51], v[60:63], v[40:43]
    ds_read_b128 v[96:99], v11 offset:0
    ds_read_b128 v[100:103], v12 offset:0
    v_mfma_f32_16x16x32_bf16 v[44:47], v[52:55], v[60:63], v[44:47]
    ds_read_b128 v[104:107], v13 offset:512
    ds_read_b128 v[108:111], v13 offset:768
    v_mfma_f32_16x16x32_bf16 v[32:35], v[64:67], v[72:75], v[32:35]
    v_subrev_u32 v11, 128, v11
    v_subrev_u32 v12, 128, v12
    v_mfma_f32_16x16x32_bf16 v[36:39], v[68:71], v[72:75], v[36:39]
    v_subrev_u32 v13, 32, v13
    v_mfma_f32_16x16x32_bf16 v[40:43], v[64:67], v[76:79], v[40:43]
    v_mfma_f32_16x16x32_bf16 v[44:47], v[68:71], v[76:79], v[44:47]
    s_waitcnt lgkmcnt(0)
    v_mfma_f32_16x16x32_bf16 v[32:35], v[80:83], v[88:91], v[32:35]
    ds_read_b128 v[48:51], v11 offset:64
    ds_read_b128 v[52:55], v12 offset:64
    v_mfma_f32_16x16x32_bf16 v[36:39], v[84:87], v[88:91], v[36:39]
    ds_read_b128 v[56:59], v13 offset:528
    ds_read_b128 v[60:63], v13 offset:784
    v_mfma_f32_16x16x32_bf16 v[40:43], v[80:83], v[92:95], v[40:43]
    ds_read_b128 v[64:67], v11 offset:0
    ds_read_b128 v[68:71], v12 offset:0
    v_mfma_f32_16x16x32_bf16 v[44:47], v[84:87], v[92:95], v[44:47]
    ds_read_b128 v[72:75], v13 offset:512
    ds_read_b128 v[76:79], v13 offset:768
    v_mfma_f32_16x16x32_bf16 v[32:35], v[96:99], v[104:107], v[32:35]
    v_subrev_u32 v11, 128, v11
    v_subrev_u32 v12, 128, v12
    v_mfma_f32_16x16x32_bf16 v[36:39], v[100:103], v[104:107], v[36:39]
    v_subrev_u32 v13, 32, v13
    v_mfma_f32_16x16x32_bf16 v[40:43], v[96:99], v[108:111], v[40:43]
    v_mfma_f32_16x16x32_bf16 v[44:47], v[100:103], v[108:111], v[44:47]
    s_sub_u32 s48, s48, 1
    s_cmp_lg_u32 s48, 0
    s_cbranch_scc1 c2_b1
    s_waitcnt lgkmcnt(0)
c2_pd:
    s_nop 7
    s_barrier
    v_lshlrev_b32 v2, 4, v1
    s_lshl_b32 s42, s28, 12
    v_add_u32 v3, s42, v2
    s_cmp_eq_u32 s41, 0
    s_cbranch_scc0 c2_x1
    ds_write_b128 v3, v[32:35] offset:0
    ds_write_b128 v3, v[36:39] offset:1024
    ds_write_b128 v3, v[40:43] offset:2048
    ds_write_b128 v3, v[44:47] offset:3072
    s_branch c2_x2
c2_x1:
    ds_write_b128 v3, v[24:27] offset:0
    ds_write_b128 v3, v[28:31] offset:1024
c2_x2:
    s_waitcnt lgkmcnt(0)
    s_barrier
    s_xor_b32 s42, s28, 1
    s_lshl_b32 s42, s42, 12
    v_add_u32 v3, s42, v2
    s_lshl_b32 s44, s32, 1
    s_add_u32 s44, s44, s40
    s_lshl_b32 s44, s44, 12
    s_add_u32 s44, s44, 12582912
    v_lshrrev_b32 v4, 4, v1
    v_and_b32 v5, 15, v1
    v_lshlrev_b32 v5, 4, v5
    v_lshl_add_u32 v5, v4, 10, v5
    s_cmp_eq_u32 s41, 0
    s_cbranch_scc0 c2_f1
    ds_read_b128 v[56:59], v3 offset:0
    ds_read_b128 v[60:63], v3 offset:1024
    v_cvt_pk_bf16_f32 v48, v16, v17
    v_cvt_pk_bf16_f32 v49, v18, v19
    v_cvt_pk_bf16_f32 v50, v20, v21
    v_cvt_pk_bf16_f32 v51, v22, v23
    buffer_store_dwordx4 v[48:51], v5, s[36:39], s44 offen offset:0 sc1
    s_waitcnt lgkmcnt(0)
    v_add_f32 v24, v24, v56
    v_add_f32 v25, v25, v57
    v_add_f32 v26, v26, v58
    v_add_f32 v27, v27, v59
    v_add_f32 v28, v28, v60
    v_add_f32 v29, v29, v61
    v_add_f32 v30, v30, v62
    v_add_f32 v31, v31, v63
    v_cvt_pk_bf16_f32 v52, v24, v25
    v_cvt_pk_bf16_f32 v53, v26, v27
    v_cvt_pk_bf16_f32 v54, v28, v29
    v_cvt_pk_bf16_f32 v55, v30, v31
    buffer_store_dwordx4 v[52:55], v5, s[36:39], s44 offen offset:256 sc1
    s_branch c2_fd
c2_f1:
    ds_read_b128 v[56:59], v3 offset:0
    ds_read_b128 v[60:63], v3 offset:1024
    ds_read_b128 v[64:67], v3 offset:2048
    ds_read_b128 v[68:71], v3 offset:3072
    s_waitcnt lgkmcnt(0)
    v_add_f32 v32, v32, v56
    v_add_f32 v33, v33, v57
    v_add_f32 v34, v34, v58
    v_add_f32 v35, v35, v59
    v_add_f32 v36, v36, v60
    v_add_f32 v37, v37, v61
    v_add_f32 v38, v38, v62
    v_add_f32 v39, v39, v63
    v_add_f32 v40, v40, v64
    v_add_f32 v41, v41, v65
    v_add_f32 v42, v42, v66
    v_add_f32 v43, v43, v67
    v_add_f32 v44, v44, v68
    v_add_f32 v45, v45, v69
    v_add_f32 v46, v46, v70
    v_add_f32 v47, v47, v71
    v_cvt_pk_bf16_f32 v48, v32, v33
    v_cvt_pk_bf16_f32 v49, v34, v35
    v_cvt_pk_bf16_f32 v50, v36, v37
    v_cvt_pk_bf16_f32 v51, v38, v39
    buffer_store_dwordx4 v[48:51], v5, s[36:39], s44 offen offset:512 sc1
    v_cvt_pk_bf16_f32 v52, v40, v41
    v_cvt_pk_bf16_f32 v53, v42, v43
    v_cvt_pk_bf16_f32 v54, v44, v45
    v_cvt_pk_bf16_f32 v55, v46, v47
    buffer_store_dwordx4 v[52:55], v5, s[36:39], s44 offen offset:768 sc1
c2_fd:
    s_waitcnt vmcnt(0)
    s_barrier
    s_cmp_lg_u32 s28, 0
    s_cbranch_scc1 c_end
    s_lshl_b32 s44, s32, 7
    s_add_u32 s44, s44, 15007744
    v_mov_b32 v2, s86
    v_mov_b32 v3, 0
    v_cmp_eq_u32 vcc, 0, v1
    s_and_saveexec_b64 s[46:47], vcc
    buffer_store_dword v2, v3, s[36:39], s44 offen sc1
    s_mov_b64 exec, s[46:47]
c_end:
    s_endpgm
k_g:
    s_setprio 3
    s_load_dwordx2 s[4:5], s[0:1], 0
    s_load_dwordx2 s[6:7], s[0:1], 64
    s_load_dwordx2 s[8:9], s[0:1], 72
    s_load_dwordx2 s[10:11], s[0:1], 112
    s_load_dwordx2 s[34:35], s[0:1], 104
    s_load_dwordx2 s[84:85], s[0:1], 88
    s_load_dwordx2 s[86:87], s[0:1], 96
    s_load_dwordx2 s[88:89], s[0:1], 80
    v_and_b32 v1, 63, v0
    v_lshrrev_b32 v2, 6, v0
    s_sub_u32 s33, s2, 256
    s_and_b32 s37, s33, 7
    s_lshr_b32 s36, s33, 3
    v_readfirstlane_b32 s28, v2
    s_lshr_b32 s29, s37, 1
    s_and_b32 s30, s37, 1
    s_lshl_b32 s29, s29, 2
    s_and_b32 s37, s36, 3
    s_add_u32 s29, s29, s37
    s_lshl_b32 s30, s30, 3
    s_lshr_b32 s37, s36, 2
    s_add_u32 s30, s30, s37
    s_mul_i32 s31, s30, 3
    s_lshl_b32 s37, s30, 1
    s_add_u32 s37, s37, 11
    s_cmp_lt_u32 s30, 11
    s_cselect_b32 s31, s31, s37
    s_lshl_b32 s36, s31, 6
    s_mov_b32 s40, s28
    v_lshrrev_b32 v2, 3, v1
    v_and_b32 v3, 7, v1
    v_lshrrev_b32 v4, 1, v2
    v_xor_b32 v3, v3, v4
    v_lshlrev_b32 v3, 4, v3
    v_lshl_add_u32 v128, v2, 10, v3
    s_lshl_b32 s37, s29, 7
    s_lshl_b32 s38, s40, 5
    s_add_u32 s37, s37, s38
    s_lshl_b32 s37, s37, 10
    v_add_u32 v128, s37, v128
    v_xor_b32 v130, 64, v128
    s_lshl_b32 s37, s40, 1
    s_add_u32 s38, s40, 2
    s_cmp_lt_u32 s40, 2
    s_cselect_b32 s41, s37, s38
    s_mov_b32 s39, 0xaaab
    s_add_u32 s37, s41, 0
    s_lshl_b32 s37, s37, 6
    v_add_u32 v2, s37, v1
    v_mul_u32_u24 v3, s39, v2
    v_lshrrev_b32 v3, 19, v3
    v_mul_u32_u24 v4, 12, v3
    v_sub_u32 v4, v2, v4
    v_mul_u32_u24 v3, 2752, v3
    v_lshlrev_b32 v4, 4, v4
    v_add3_u32 v129, v3, v4, s36
    s_add_u32 s37, s41, 1
    s_lshl_b32 s37, s37, 6
    v_add_u32 v2, s37, v1
    v_mul_u32_u24 v3, s39, v2
    v_lshrrev_b32 v3, 19, v3
    v_mul_u32_u24 v4, 12, v3
    v_sub_u32 v4, v2, v4
    v_mul_u32_u24 v3, 2752, v3
    v_lshlrev_b32 v4, 4, v4
    v_add3_u32 v131, v3, v4, s36
    s_lshl_b32 s42, s40, 12
    s_lshl_b32 s43, s41, 10
    s_add_u32 s43, s43, 49152
    s_add_u32 s44, s43, 1024
    s_and_b32 s38, s29, 3
    s_lshl_b32 s38, s38, 1
    s_add_u32 s38, s38, s30
    s_and_b32 s38, s38, 7
    s_mov_b32 s94, s38
    s_lshl_b32 s38, s38, 7
    s_mov_b32 s39, s38
    s_waitcnt lgkmcnt(0)
    s_mov_b32 s12, s4
    s_mov_b32 s13, s5
    s_mov_b32 s14, 0x200000
    s_mov_b32 s15, 0x00020000
    s_mov_b32 s16, s6
    s_mov_b32 s17, s7
    s_mov_b32 s18, 0x158000
    s_mov_b32 s19, 0x00020000
    s_cmp_lt_u32 s28, 2
    s_cbranch_scc1 g_v2
    s_add_u32 m0, s42, 0
    s_add_u32 s48, s38, 0
    buffer_load_dwordx4 v128, s[12:15], s48 offen lds
    s_add_u32 m0, s42, 1024
    s_add_u32 s48, s38, 8192
    buffer_load_dwordx4 v130, s[12:15], s48 offen lds
    s_add_u32 m0, s42, 2048
    s_add_u32 s48, s38, 16384
    buffer_load_dwordx4 v128, s[12:15], s48 offen lds
    s_add_u32 m0, s42, 3072
    s_add_u32 s48, s38, 24576
    buffer_load_dwordx4 v130, s[12:15], s48 offen lds
    s_add_u32 s38, s38, 128
    s_and_b32 s38, s38, 0x3ff
    s_add_u32 m0, s43, 0
    s_mul_i32 s48, s39, 1376
    buffer_load_dwordx4 v129, s[16:19], s48 offen lds
    s_add_u32 s39, s39, 64
    s_and_b32 s39, s39, 0x3ff
    s_add_u32 m0, s43, 6144
    s_mul_i32 s48, s39, 1376
    buffer_load_dwordx4 v129, s[16:19], s48 offen lds
    s_add_u32 s39, s39, 64
    s_and_b32 s39, s39, 0x3ff
    s_mov_b32 s20, s8
    s_mov_b32 s21, s9
    s_mov_b32 s22, 0xac0
    s_mov_b32 s23, 0x00020000
    s_mov_b32 s24, s10
    s_mov_b32 s25, s11
    s_mov_b32 s26, 0x1000000
    s_mov_b32 s27, 0x00020000
    s_mov_b32 s52, s34
    s_mov_b32 s53, s35
    s_mov_b32 s54, 0x100
    s_mov_b32 s55, 0x00020000
    v_and_b32 v2, 31, v1
    v_lshrrev_b32 v3, 5, v1
    v_bfe_u32 v12, v2, 1, 3
    v_xor_b32 v3, v3, v12
    v_lshlrev_b32 v3, 4, v3
    v_lshl_add_u32 v116, v2, 7, v3
    s_lshl_b32 s37, s28, 12
    v_add_u32 v116, s37, v116
    v_xor_b32 v117, 32, v116
    v_xor_b32 v118, 64, v116
    v_xor_b32 v119, 96, v116
    v_lshrrev_b32 v2, 4, v1
    v_bfe_u32 v3, v1, 2, 2
    v_and_b32 v12, 3, v1
    v_lshrrev_b32 v13, 1, v2
    v_and_b32 v2, 1, v2
    v_lshl_add_u32 v2, v2, 2, v12
    v_and_b32 v12, 1, v2
    v_lshlrev_b32 v12, 4, v12
    v_lshrrev_b32 v2, 1, v2
    v_lshl_add_u32 v12, v2, 2, v12
    v_lshl_add_u32 v13, v13, 3, v3
    v_mul_u32_u24 v13, 192, v13
    v_lshl_add_u32 v120, v12, 1, v13
    v_add_u32 v120, 49152, v120
    v_bfe_u32 v2, v1, 4, 1
    v_lshlrev_b32 v2, 10, v2
    v_and_b32 v3, 15, v1
    v_lshl_add_u32 v2, v3, 4, v2
    v_lshrrev_b32 v3, 5, v1
    v_lshl_add_u32 v121, v3, 9, v2
    s_lshl_b32 s60, s29, 1
    s_lshr_b32 s47, s28, 1
    s_add_u32 s60, s60, s47
    s_mul_i32 s60, s60, 176128
    s_and_b32 s47, s28, 1
    s_lshl_b32 s47, s47, 11
    s_add_u32 s60, s60, s47
    s_lshl_b32 s47, s31, 12
    s_add_u32 s60, s60, s47
    s_lshl_b32 s37, s29, 7
    s_lshl_b32 s58, s28, 5
    s_add_u32 s37, s37, s58
    v_and_b32 v2, 31, v1
    v_add_u32 v2, s37, v2
    v_lshlrev_b32 v122, 5, v2
    v_add_u32 v122, 14680064, v122
    v_lshlrev_b32 v123, 4, v1
    v_cmp_gt_u32 s[62:63], 32, v1
    s_add_u32 s37, s31, s40
    s_lshl_b32 s37, s37, 10
    s_add_u32 s37, s37, 14745600
    v_add_u32 v164, s37, v123
    v_mov_b32 v165, 0
    v_bfe_u32 v2, v1, 2, 1
    v_lshlrev_b32 v2, 4, v2
    v_bfe_u32 v3, v1, 3, 2
    v_lshl_add_u32 v2, v3, 2, v2
    v_and_b32 v3, 3, v1
    v_add_u32 v162, v2, v3
    s_lshl_b32 s37, s40, 6
    s_add_u32 s37, s37, s36
    v_lshlrev_b32 v2, 1, v162
    v_add_u32 v163, s37, v2
    v_mov_b32 v68, 0
    v_mov_b32 v69, 0
    v_mov_b32 v70, 0
    v_mov_b32 v71, 0
    v_mov_b32 v72, 0
    v_mov_b32 v73, 0
    v_mov_b32 v74, 0
    v_mov_b32 v75, 0
    v_mov_b32 v76, 0
    v_mov_b32 v77, 0
    v_mov_b32 v78, 0
    v_mov_b32 v79, 0
    v_mov_b32 v80, 0
    v_mov_b32 v81, 0
    v_mov_b32 v82, 0
    v_mov_b32 v83, 0
    v_mov_b32 v84, 0
    v_mov_b32 v85, 0
    v_mov_b32 v86, 0
    v_mov_b32 v87, 0
    v_mov_b32 v88, 0
    v_mov_b32 v89, 0
    v_mov_b32 v90, 0
    v_mov_b32 v91, 0
    v_mov_b32 v92, 0
    v_mov_b32 v93, 0
    v_mov_b32 v94, 0
    v_mov_b32 v95, 0
    v_mov_b32 v96, 0
    v_mov_b32 v97, 0
    v_mov_b32 v98, 0
    v_mov_b32 v99, 0
    v_mov_b32 v100, 0
    v_mov_b32 v101, 0
    v_mov_b32 v102, 0
    v_mov_b32 v103, 0
    v_mov_b32 v104, 0
    v_mov_b32 v105, 0
    v_mov_b32 v106, 0
    v_mov_b32 v107, 0
    v_mov_b32 v108, 0
    v_mov_b32 v109, 0
    v_mov_b32 v110, 0
    v_mov_b32 v111, 0
    v_mov_b32 v112, 0
    v_mov_b32 v113, 0
    v_mov_b32 v114, 0
    v_mov_b32 v115, 0
    s_waitcnt vmcnt(1) lgkmcnt(0)
    s_barrier
    ds_read_b128 v[4:7], v116 offset:0
    ds_read_b64_tr_b16 v[8:9], v120 offset:0
    ds_read_b64_tr_b16 v[10:11], v120 offset:768
    ds_read_b64_tr_b16 v[12:13], v120 offset:64
    ds_read_b64_tr_b16 v[14:15], v120 offset:832
    ds_read_b64_tr_b16 v[16:17], v120 offset:128
    ds_read_b64_tr_b16 v[18:19], v120 offset:896
    ds_read_b128 v[20:23], v117 offset:0
    ds_read_b64_tr_b16 v[24:25], v120 offset:3072
    ds_read_b64_tr_b16 v[26:27], v120 offset:3840
    ds_read_b64_tr_b16 v[28:29], v120 offset:3136
    ds_read_b64_tr_b16 v[30:31], v120 offset:3904
    ds_read_b64_tr_b16 v[32:33], v120 offset:3200
    ds_read_b64_tr_b16 v[34:35], v120 offset:3968
    s_add_u32 m0, s42, 16384
    s_add_u32 s48, s38, 0
    buffer_load_dwordx4 v128, s[12:15], s48 offen lds
    s_add_u32 m0, s42, 17408
    s_add_u32 s48, s38, 8192
    buffer_load_dwordx4 v130, s[12:15], s48 offen lds
    s_add_u32 m0, s42, 18432
    s_add_u32 s48, s38, 16384
    buffer_load_dwordx4 v128, s[12:15], s48 offen lds
    s_add_u32 m0, s42, 19456
    s_add_u32 s48, s38, 24576
    buffer_load_dwordx4 v130, s[12:15], s48 offen lds
    s_add_u32 s38, s38, 128
    s_and_b32 s38, s38, 0x3ff
    s_add_u32 m0, s43, 12288
    s_mul_i32 s48, s39, 1376
    buffer_load_dwordx4 v129, s[16:19], s48 offen lds
    s_add_u32 s39, s39, 64
    s_and_b32 s39, s39, 0x3ff
    s_add_u32 m0, s43, 18432
    s_mul_i32 s48, s39, 1376
    buffer_load_dwordx4 v129, s[16:19], s48 offen lds
    s_add_u32 s39, s39, 64
    s_and_b32 s39, s39, 0x3ff
    s_waitcnt vmcnt(6) lgkmcnt(0)
    s_barrier
    v_mfma_f32_32x32x16_bf16 v[68:83], v[8:11], v[4:7], v[68:83]
    ds_read_b128 v[36:39], v118 offset:0
    ds_read_b64_tr_b16 v[40:41], v120 offset:6144
    ds_read_b64_tr_b16 v[42:43], v120 offset:6912
    s_add_u32 m0, s42, 32768
    s_add_u32 s48, s38, 0
    buffer_load_dwordx4 v128, s[12:15], s48 offen lds
    v_mfma_f32_32x32x16_bf16 v[84:99], v[12:15], v[4:7], v[84:99]
    ds_read_b64_tr_b16 v[44:45], v120 offset:6208
    ds_read_b64_tr_b16 v[46:47], v120 offset:6976
    ds_read_b64_tr_b16 v[48:49], v120 offset:6272
    s_add_u32 m0, s42, 33792
    s_add_u32 s48, s38, 8192
    buffer_load_dwordx4 v130, s[12:15], s48 offen lds
    v_mfma_f32_32x32x16_bf16 v[100:115], v[16:19], v[4:7], v[100:115]
    ds_read_b64_tr_b16 v[50:51], v120 offset:7040
    ds_read_b128 v[52:55], v119 offset:0
    ds_read_b64_tr_b16 v[56:57], v120 offset:9216
    s_add_u32 m0, s43, 24576
    s_mul_i32 s48, s39, 1376
    buffer_load_dwordx4 v129, s[16:19], s48 offen lds
    v_mfma_f32_32x32x16_bf16 v[68:83], v[24:27], v[20:23], v[68:83]
    ds_read_b64_tr_b16 v[58:59], v120 offset:9984
    ds_read_b64_tr_b16 v[60:61], v120 offset:9280
    ds_read_b64_tr_b16 v[62:63], v120 offset:10048
    s_add_u32 s39, s39, 64
    s_and_b32 s39, s39, 0x3ff
    s_add_u32 m0, s42, 34816
    s_add_u32 s48, s38, 16384
    buffer_load_dwordx4 v128, s[12:15], s48 offen lds
    v_mfma_f32_32x32x16_bf16 v[84:99], v[28:31], v[20:23], v[84:99]
    ds_read_b64_tr_b16 v[64:65], v120 offset:9344
    ds_read_b64_tr_b16 v[66:67], v120 offset:10112
    s_add_u32 m0, s42, 35840
    s_add_u32 s48, s38, 24576
    buffer_load_dwordx4 v130, s[12:15], s48 offen lds
    v_mfma_f32_32x32x16_bf16 v[100:115], v[32:35], v[20:23], v[100:115]
    s_add_u32 s38, s38, 128
    s_and_b32 s38, s38, 0x3ff
    s_add_u32 m0, s43, 0
    s_mul_i32 s48, s39, 1376
    buffer_load_dwordx4 v129, s[16:19], s48 offen lds
    s_add_u32 s39, s39, 64
    s_and_b32 s39, s39, 0x3ff
    s_waitcnt vmcnt(7) lgkmcnt(0)
    s_barrier
    v_mfma_f32_32x32x16_bf16 v[68:83], v[40:43], v[36:39], v[68:83]
    ds_read_b128 v[4:7], v116 offset:16384
    ds_read_b64_tr_b16 v[8:9], v120 offset:12288
    ds_read_b64_tr_b16 v[10:11], v120 offset:13056
    s_add_u32 m0, s42, 0
    s_add_u32 s48, s38, 0
    buffer_load_dwordx4 v128, s[12:15], s48 offen lds
    v_mfma_f32_32x32x16_bf16 v[84:99], v[44:47], v[36:39], v[84:99]
    ds_read_b64_tr_b16 v[12:13], v120 offset:12352
    ds_read_b64_tr_b16 v[14:15], v120 offset:13120
    ds_read_b64_tr_b16 v[16:17], v120 offset:12416
    v_mfma_f32_32x32x16_bf16 v[100:115], v[48:51], v[36:39], v[100:115]
    ds_read_b64_tr_b16 v[18:19], v120 offset:13184
    ds_read_b128 v[20:23], v117 offset:16384
    ds_read_b64_tr_b16 v[24:25], v120 offset:15360
    s_add_u32 m0, s42, 1024
    s_add_u32 s48, s38, 8192
    buffer_load_dwordx4 v130, s[12:15], s48 offen lds
    v_mfma_f32_32x32x16_bf16 v[68:83], v[56:59], v[52:55], v[68:83]
    ds_read_b64_tr_b16 v[26:27], v120 offset:16128
    ds_read_b64_tr_b16 v[28:29], v120 offset:15424
    ds_read_b64_tr_b16 v[30:31], v120 offset:16192
    v_mfma_f32_32x32x16_bf16 v[84:99], v[60:63], v[52:55], v[84:99]
    ds_read_b64_tr_b16 v[32:33], v120 offset:15488
    ds_read_b64_tr_b16 v[34:35], v120 offset:16256
    s_add_u32 m0, s43, 6144
    s_mul_i32 s48, s39, 1376
    buffer_load_dwordx4 v129, s[16:19], s48 offen lds
    s_add_u32 s39, s39, 64
    s_and_b32 s39, s39, 0x3ff
    v_mfma_f32_32x32x16_bf16 v[100:115], v[64:67], v[52:55], v[100:115]
    s_waitcnt vmcnt(9) lgkmcnt(0)
    s_barrier
    v_mfma_f32_32x32x16_bf16 v[68:83], v[8:11], v[4:7], v[68:83]
    ds_read_b128 v[36:39], v118 offset:16384
    ds_read_b64_tr_b16 v[40:41], v120 offset:18432
    ds_read_b64_tr_b16 v[42:43], v120 offset:19200
    s_add_u32 m0, s42, 2048
    s_add_u32 s48, s38, 16384
    buffer_load_dwordx4 v128, s[12:15], s48 offen lds
    v_mfma_f32_32x32x16_bf16 v[84:99], v[12:15], v[4:7], v[84:99]
    ds_read_b64_tr_b16 v[44:45], v120 offset:18496
    ds_read_b64_tr_b16 v[46:47], v120 offset:19264
    ds_read_b64_tr_b16 v[48:49], v120 offset:18560
    v_mfma_f32_32x32x16_bf16 v[100:115], v[16:19], v[4:7], v[100:115]
    ds_read_b64_tr_b16 v[50:51], v120 offset:19328
    ds_read_b128 v[52:55], v119 offset:16384
    ds_read_b64_tr_b16 v[56:57], v120 offset:21504
    s_add_u32 m0, s42, 3072
    s_add_u32 s48, s38, 24576
    buffer_load_dwordx4 v130, s[12:15], s48 offen lds
    v_mfma_f32_32x32x16_bf16 v[68:83], v[24:27], v[20:23], v[68:83]
    ds_read_b64_tr_b16 v[58:59], v120 offset:22272
    ds_read_b64_tr_b16 v[60:61], v120 offset:21568
    ds_read_b64_tr_b16 v[62:63], v120 offset:22336
    v_mfma_f32_32x32x16_bf16 v[84:99], v[28:31], v[20:23], v[84:99]
    ds_read_b64_tr_b16 v[64:65], v120 offset:21632
    ds_read_b64_tr_b16 v[66:67], v120 offset:22400
    s_add_u32 s38, s38, 128
    s_and_b32 s38, s38, 0x3ff
    s_add_u32 m0, s43, 12288
    s_mul_i32 s48, s39, 1376
    buffer_load_dwordx4 v129, s[16:19], s48 offen lds
    s_add_u32 s39, s39, 64
    s_and_b32 s39, s39, 0x3ff
    v_mfma_f32_32x32x16_bf16 v[100:115], v[32:35], v[20:23], v[100:115]
    s_waitcnt vmcnt(7) lgkmcnt(0)
    s_barrier
    v_mfma_f32_32x32x16_bf16 v[68:83], v[40:43], v[36:39], v[68:83]
    ds_read_b128 v[4:7], v116 offset:32768
    ds_read_b64_tr_b16 v[8:9], v120 offset:24576
    ds_read_b64_tr_b16 v[10:11], v120 offset:25344
    s_add_u32 m0, s42, 16384
    s_add_u32 s48, s38, 0
    buffer_load_dwordx4 v128, s[12:15], s48 offen lds
    v_mfma_f32_32x32x16_bf16 v[84:99], v[44:47], v[36:39], v[84:99]
    ds_read_b64_tr_b16 v[12:13], v120 offset:24640
    ds_read_b64_tr_b16 v[14:15], v120 offset:25408
    ds_read_b64_tr_b16 v[16:17], v120 offset:24704
    v_mfma_f32_32x32x16_bf16 v[100:115], v[48:51], v[36:39], v[100:115]
    ds_read_b64_tr_b16 v[18:19], v120 offset:25472
    ds_read_b128 v[20:23], v117 offset:32768
    ds_read_b64_tr_b16 v[24:25], v120 offset:27648
    s_add_u32 m0, s42, 17408
    s_add_u32 s48, s38, 8192
    buffer_load_dwordx4 v130, s[12:15], s48 offen lds
    v_mfma_f32_32x32x16_bf16 v[68:83], v[56:59], v[52:55], v[68:83]
    ds_read_b64_tr_b16 v[26:27], v120 offset:28416
    ds_read_b64_tr_b16 v[28:29], v120 offset:27712
    ds_read_b64_tr_b16 v[30:31], v120 offset:28480
    v_mfma_f32_32x32x16_bf16 v[84:99], v[60:63], v[52:55], v[84:99]
    ds_read_b64_tr_b16 v[32:33], v120 offset:27776
    ds_read_b64_tr_b16 v[34:35], v120 offset:28544
    s_add_u32 m0, s43, 18432
    s_mul_i32 s48, s39, 1376
    buffer_load_dwordx4 v129, s[16:19], s48 offen lds
    s_add_u32 s39, s39, 64
    s_and_b32 s39, s39, 0x3ff
    v_mfma_f32_32x32x16_bf16 v[100:115], v[64:67], v[52:55], v[100:115]
    s_waitcnt vmcnt(9) lgkmcnt(0)
    s_barrier
    v_mfma_f32_32x32x16_bf16 v[68:83], v[8:11], v[4:7], v[68:83]
    ds_read_b128 v[36:39], v118 offset:32768
    ds_read_b64_tr_b16 v[40:41], v120 offset:0
    ds_read_b64_tr_b16 v[42:43], v120 offset:768
    s_add_u32 m0, s42, 18432
    s_add_u32 s48, s38, 16384
    buffer_load_dwordx4 v128, s[12:15], s48 offen lds
    v_mfma_f32_32x32x16_bf16 v[84:99], v[12:15], v[4:7], v[84:99]
    ds_read_b64_tr_b16 v[44:45], v120 offset:64
    ds_read_b64_tr_b16 v[46:47], v120 offset:832
    ds_read_b64_tr_b16 v[48:49], v120 offset:128
    v_mfma_f32_32x32x16_bf16 v[100:115], v[16:19], v[4:7], v[100:115]
    ds_read_b64_tr_b16 v[50:51], v120 offset:896
    ds_read_b128 v[52:55], v119 offset:32768
    ds_read_b64_tr_b16 v[56:57], v120 offset:3072
    s_add_u32 m0, s42, 19456
    s_add_u32 s48, s38, 24576
    buffer_load_dwordx4 v130, s[12:15], s48 offen lds
    v_mfma_f32_32x32x16_bf16 v[68:83], v[24:27], v[20:23], v[68:83]
    ds_read_b64_tr_b16 v[58:59], v120 offset:3840
    ds_read_b64_tr_b16 v[60:61], v120 offset:3136
    ds_read_b64_tr_b16 v[62:63], v120 offset:3904
    v_mfma_f32_32x32x16_bf16 v[84:99], v[28:31], v[20:23], v[84:99]
    ds_read_b64_tr_b16 v[64:65], v120 offset:3200
    ds_read_b64_tr_b16 v[66:67], v120 offset:3968
    s_add_u32 s38, s38, 128
    s_and_b32 s38, s38, 0x3ff
    s_add_u32 m0, s43, 24576
    s_mul_i32 s48, s39, 1376
    buffer_load_dwordx4 v129, s[16:19], s48 offen lds
    s_add_u32 s39, s39, 64
    s_and_b32 s39, s39, 0x3ff
    v_mfma_f32_32x32x16_bf16 v[100:115], v[32:35], v[20:23], v[100:115]
    s_waitcnt vmcnt(7) lgkmcnt(0)
    s_barrier
    v_mfma_f32_32x32x16_bf16 v[68:83], v[40:43], v[36:39], v[68:83]
    ds_read_b128 v[4:7], v116 offset:0
    ds_read_b64_tr_b16 v[8:9], v120 offset:6144
    ds_read_b64_tr_b16 v[10:11], v120 offset:6912
    s_add_u32 m0, s42, 32768
    s_add_u32 s48, s38, 0
    buffer_load_dwordx4 v128, s[12:15], s48 offen lds
    v_mfma_f32_32x32x16_bf16 v[84:99], v[44:47], v[36:39], v[84:99]
    ds_read_b64_tr_b16 v[12:13], v120 offset:6208
    ds_read_b64_tr_b16 v[14:15], v120 offset:6976
    ds_read_b64_tr_b16 v[16:17], v120 offset:6272
    v_mfma_f32_32x32x16_bf16 v[100:115], v[48:51], v[36:39], v[100:115]
    ds_read_b64_tr_b16 v[18:19], v120 offset:7040
    ds_read_b128 v[20:23], v117 offset:0
    ds_read_b64_tr_b16 v[24:25], v120 offset:9216
    s_add_u32 m0, s42, 33792
    s_add_u32 s48, s38, 8192
    buffer_load_dwordx4 v130, s[12:15], s48 offen lds
    v_mfma_f32_32x32x16_bf16 v[68:83], v[56:59], v[52:55], v[68:83]
    ds_read_b64_tr_b16 v[26:27], v120 offset:9984
    ds_read_b64_tr_b16 v[28:29], v120 offset:9280
    ds_read_b64_tr_b16 v[30:31], v120 offset:10048
    v_mfma_f32_32x32x16_bf16 v[84:99], v[60:63], v[52:55], v[84:99]
    ds_read_b64_tr_b16 v[32:33], v120 offset:9344
    ds_read_b64_tr_b16 v[34:35], v120 offset:10112
    s_add_u32 m0, s43, 0
    s_mul_i32 s48, s39, 1376
    buffer_load_dwordx4 v129, s[16:19], s48 offen lds
    s_add_u32 s39, s39, 64
    s_and_b32 s39, s39, 0x3ff
    v_mfma_f32_32x32x16_bf16 v[100:115], v[64:67], v[52:55], v[100:115]
    s_waitcnt vmcnt(9) lgkmcnt(0)
    s_barrier
    v_mfma_f32_32x32x16_bf16 v[68:83], v[8:11], v[4:7], v[68:83]
    ds_read_b128 v[36:39], v118 offset:0
    ds_read_b64_tr_b16 v[40:41], v120 offset:12288
    ds_read_b64_tr_b16 v[42:43], v120 offset:13056
    s_add_u32 m0, s42, 34816
    s_add_u32 s48, s38, 16384
    buffer_load_dwordx4 v128, s[12:15], s48 offen lds
    v_mfma_f32_32x32x16_bf16 v[84:99], v[12:15], v[4:7], v[84:99]
    ds_read_b64_tr_b16 v[44:45], v120 offset:12352
    ds_read_b64_tr_b16 v[46:47], v120 offset:13120
    ds_read_b64_tr_b16 v[48:49], v120 offset:12416
    v_mfma_f32_32x32x16_bf16 v[100:115], v[16:19], v[4:7], v[100:115]
    ds_read_b64_tr_b16 v[50:51], v120 offset:13184
    ds_read_b128 v[52:55], v119 offset:0
    ds_read_b64_tr_b16 v[56:57], v120 offset:15360
    s_add_u32 m0, s42, 35840
    s_add_u32 s48, s38, 24576
    buffer_load_dwordx4 v130, s[12:15], s48 offen lds
    v_mfma_f32_32x32x16_bf16 v[68:83], v[24:27], v[20:23], v[68:83]
    ds_read_b64_tr_b16 v[58:59], v120 offset:16128
    ds_read_b64_tr_b16 v[60:61], v120 offset:15424
    ds_read_b64_tr_b16 v[62:63], v120 offset:16192
    v_mfma_f32_32x32x16_bf16 v[84:99], v[28:31], v[20:23], v[84:99]
    ds_read_b64_tr_b16 v[64:65], v120 offset:15488
    ds_read_b64_tr_b16 v[66:67], v120 offset:16256
    s_add_u32 s38, s38, 128
    s_and_b32 s38, s38, 0x3ff
    s_add_u32 m0, s43, 6144
    s_mul_i32 s48, s39, 1376
    buffer_load_dwordx4 v129, s[16:19], s48 offen lds
    s_add_u32 s39, s39, 64
    s_and_b32 s39, s39, 0x3ff
    v_mfma_f32_32x32x16_bf16 v[100:115], v[32:35], v[20:23], v[100:115]
    s_waitcnt vmcnt(7) lgkmcnt(0)
    s_barrier
    v_mfma_f32_32x32x16_bf16 v[68:83], v[40:43], v[36:39], v[68:83]
    ds_read_b128 v[4:7], v116 offset:16384
    ds_read_b64_tr_b16 v[8:9], v120 offset:18432
    ds_read_b64_tr_b16 v[10:11], v120 offset:19200
    s_add_u32 m0, s42, 0
    s_add_u32 s48, s38, 0
    buffer_load_dwordx4 v128, s[12:15], s48 offen lds
    v_mfma_f32_32x32x16_bf16 v[84:99], v[44:47], v[36:39], v[84:99]
    ds_read_b64_tr_b16 v[12:13], v120 offset:18496
    ds_read_b64_tr_b16 v[14:15], v120 offset:19264
    ds_read_b64_tr_b16 v[16:17], v120 offset:18560
    v_mfma_f32_32x32x16_bf16 v[100:115], v[48:51], v[36:39], v[100:115]
    ds_read_b64_tr_b16 v[18:19], v120 offset:19328
    ds_read_b128 v[20:23], v117 offset:16384
    ds_read_b64_tr_b16 v[24:25], v120 offset:21504
    s_add_u32 m0, s42, 1024
    s_add_u32 s48, s38, 8192
    buffer_load_dwordx4 v130, s[12:15], s48 offen lds
    v_mfma_f32_32x32x16_bf16 v[68:83], v[56:59], v[52:55], v[68:83]
    ds_read_b64_tr_b16 v[26:27], v120 offset:22272
    ds_read_b64_tr_b16 v[28:29], v120 offset:21568
    ds_read_b64_tr_b16 v[30:31], v120 offset:22336
    v_mfma_f32_32x32x16_bf16 v[84:99], v[60:63], v[52:55], v[84:99]
    ds_read_b64_tr_b16 v[32:33], v120 offset:21632
    ds_read_b64_tr_b16 v[34:35], v120 offset:22400
    s_add_u32 m0, s43, 12288
    s_mul_i32 s48, s39, 1376
    buffer_load_dwordx4 v129, s[16:19], s48 offen lds
    s_add_u32 s39, s39, 64
    s_and_b32 s39, s39, 0x3ff
    v_mfma_f32_32x32x16_bf16 v[100:115], v[64:67], v[52:55], v[100:115]
    s_waitcnt vmcnt(9) lgkmcnt(0)
    s_barrier
    v_mfma_f32_32x32x16_bf16 v[68:83], v[8:11], v[4:7], v[68:83]
    ds_read_b128 v[36:39], v118 offset:16384
    ds_read_b64_tr_b16 v[40:41], v120 offset:24576
    ds_read_b64_tr_b16 v[42:43], v120 offset:25344
    s_add_u32 m0, s42, 2048
    s_add_u32 s48, s38, 16384
    buffer_load_dwordx4 v128, s[12:15], s48 offen lds
    v_mfma_f32_32x32x16_bf16 v[84:99], v[12:15], v[4:7], v[84:99]
    ds_read_b64_tr_b16 v[44:45], v120 offset:24640
    ds_read_b64_tr_b16 v[46:47], v120 offset:25408
    ds_read_b64_tr_b16 v[48:49], v120 offset:24704
    v_mfma_f32_32x32x16_bf16 v[100:115], v[16:19], v[4:7], v[100:115]
    ds_read_b64_tr_b16 v[50:51], v120 offset:25472
    ds_read_b128 v[52:55], v119 offset:16384
    ds_read_b64_tr_b16 v[56:57], v120 offset:27648
    s_add_u32 m0, s42, 3072
    s_add_u32 s48, s38, 24576
    buffer_load_dwordx4 v130, s[12:15], s48 offen lds
    v_mfma_f32_32x32x16_bf16 v[68:83], v[24:27], v[20:23], v[68:83]
    ds_read_b64_tr_b16 v[58:59], v120 offset:28416
    ds_read_b64_tr_b16 v[60:61], v120 offset:27712
    ds_read_b64_tr_b16 v[62:63], v120 offset:28480
    v_mfma_f32_32x32x16_bf16 v[84:99], v[28:31], v[20:23], v[84:99]
    ds_read_b64_tr_b16 v[64:65], v120 offset:27776
    ds_read_b64_tr_b16 v[66:67], v120 offset:28544
    s_add_u32 s38, s38, 128
    s_and_b32 s38, s38, 0x3ff
    s_add_u32 m0, s43, 18432
    s_mul_i32 s48, s39, 1376
    buffer_load_dwordx4 v129, s[16:19], s48 offen lds
    s_add_u32 s39, s39, 64
    s_and_b32 s39, s39, 0x3ff
    v_mfma_f32_32x32x16_bf16 v[100:115], v[32:35], v[20:23], v[100:115]
    s_waitcnt vmcnt(7) lgkmcnt(0)
    s_barrier
    v_mfma_f32_32x32x16_bf16 v[68:83], v[40:43], v[36:39], v[68:83]
    ds_read_b128 v[4:7], v116 offset:32768
    ds_read_b64_tr_b16 v[8:9], v120 offset:0
    ds_read_b64_tr_b16 v[10:11], v120 offset:768
    s_add_u32 m0, s42, 16384
    s_add_u32 s48, s38, 0
    buffer_load_dwordx4 v128, s[12:15], s48 offen lds
    v_mfma_f32_32x32x16_bf16 v[84:99], v[44:47], v[36:39], v[84:99]
    ds_read_b64_tr_b16 v[12:13], v120 offset:64
    ds_read_b64_tr_b16 v[14:15], v120 offset:832
    ds_read_b64_tr_b16 v[16:17], v120 offset:128
    v_mfma_f32_32x32x16_bf16 v[100:115], v[48:51], v[36:39], v[100:115]
    ds_read_b64_tr_b16 v[18:19], v120 offset:896
    ds_read_b128 v[20:23], v117 offset:32768
    ds_read_b64_tr_b16 v[24:25], v120 offset:3072
    s_add_u32 m0, s42, 17408
    s_add_u32 s48, s38, 8192
    buffer_load_dwordx4 v130, s[12:15], s48 offen lds
    v_mfma_f32_32x32x16_bf16 v[68:83], v[56:59], v[52:55], v[68:83]
    ds_read_b64_tr_b16 v[26:27], v120 offset:3840
    ds_read_b64_tr_b16 v[28:29], v120 offset:3136
    ds_read_b64_tr_b16 v[30:31], v120 offset:3904
    v_mfma_f32_32x32x16_bf16 v[84:99], v[60:63], v[52:55], v[84:99]
    ds_read_b64_tr_b16 v[32:33], v120 offset:3200
    ds_read_b64_tr_b16 v[34:35], v120 offset:3968
    s_add_u32 m0, s43, 24576
    s_mul_i32 s48, s39, 1376
    buffer_load_dwordx4 v129, s[16:19], s48 offen lds
    s_add_u32 s39, s39, 64
    s_and_b32 s39, s39, 0x3ff
    v_mfma_f32_32x32x16_bf16 v[100:115], v[64:67], v[52:55], v[100:115]
    buffer_load_ushort v161, v163, s[20:23], 0 offen
    buffer_load_dword v160, v165, s[52:55], 0 offen sc1
    buffer_load_dwordx4 v[124:127], v122, s[24:27], 0 offen sc1
    buffer_load_dwordx4 v[152:155], v122, s[24:27], 0 offen offset:16 sc1
    buffer_load_dwordx4 v[156:159], v164, s[24:27], 0 offen sc1
    s_waitcnt vmcnt(14) lgkmcnt(0)
    s_barrier
    v_mfma_f32_32x32x16_bf16 v[68:83], v[8:11], v[4:7], v[68:83]
    ds_read_b128 v[36:39], v118 offset:32768
    ds_read_b64_tr_b16 v[40:41], v120 offset:6144
    ds_read_b64_tr_b16 v[42:43], v120 offset:6912
    s_add_u32 m0, s42, 18432
    s_add_u32 s48, s38, 16384
    buffer_load_dwordx4 v128, s[12:15], s48 offen lds
    v_mfma_f32_32x32x16_bf16 v[84:99], v[12:15], v[4:7], v[84:99]
    ds_read_b64_tr_b16 v[44:45], v120 offset:6208
    ds_read_b64_tr_b16 v[46:47], v120 offset:6976
    ds_read_b64_tr_b16 v[48:49], v120 offset:6272
    v_mfma_f32_32x32x16_bf16 v[100:115], v[16:19], v[4:7], v[100:115]
    ds_read_b64_tr_b16 v[50:51], v120 offset:7040
    ds_read_b128 v[52:55], v119 offset:32768
    ds_read_b64_tr_b16 v[56:57], v120 offset:9216
    s_add_u32 m0, s42, 19456
    s_add_u32 s48, s38, 24576
    buffer_load_dwordx4 v130, s[12:15], s48 offen lds
    v_mfma_f32_32x32x16_bf16 v[68:83], v[24:27], v[20:23], v[68:83]
    ds_read_b64_tr_b16 v[58:59], v120 offset:9984
    ds_read_b64_tr_b16 v[60:61], v120 offset:9280
    ds_read_b64_tr_b16 v[62:63], v120 offset:10048
    v_mfma_f32_32x32x16_bf16 v[84:99], v[28:31], v[20:23], v[84:99]
    ds_read_b64_tr_b16 v[64:65], v120 offset:9344
    ds_read_b64_tr_b16 v[66:67], v120 offset:10112
    s_add_u32 s38, s38, 128
    s_and_b32 s38, s38, 0x3ff
    s_add_u32 m0, s43, 0
    s_mul_i32 s48, s39, 1376
    buffer_load_dwordx4 v129, s[16:19], s48 offen lds
    s_add_u32 s39, s39, 64
    s_and_b32 s39, s39, 0x3ff
    v_mfma_f32_32x32x16_bf16 v[100:115], v[32:35], v[20:23], v[100:115]
    s_waitcnt vmcnt(12) lgkmcnt(0)
    s_barrier
    v_mfma_f32_32x32x16_bf16 v[68:83], v[40:43], v[36:39], v[68:83]
    ds_read_b128 v[4:7], v116 offset:0
    ds_read_b64_tr_b16 v[8:9], v120 offset:12288
    ds_read_b64_tr_b16 v[10:11], v120 offset:13056
    v_mfma_f32_32x32x16_bf16 v[84:99], v[44:47], v[36:39], v[84:99]
    ds_read_b64_tr_b16 v[12:13], v120 offset:12352
    ds_read_b64_tr_b16 v[14:15], v120 offset:13120
    ds_read_b64_tr_b16 v[16:17], v120 offset:12416
    v_mfma_f32_32x32x16_bf16 v[100:115], v[48:51], v[36:39], v[100:115]
    ds_read_b64_tr_b16 v[18:19], v120 offset:13184
    ds_read_b128 v[20:23], v117 offset:0
    ds_read_b64_tr_b16 v[24:25], v120 offset:15360
    v_mfma_f32_32x32x16_bf16 v[68:83], v[56:59], v[52:55], v[68:83]
    ds_read_b64_tr_b16 v[26:27], v120 offset:16128
    ds_read_b64_tr_b16 v[28:29], v120 offset:15424
    ds_read_b64_tr_b16 v[30:31], v120 offset:16192
    v_mfma_f32_32x32x16_bf16 v[84:99], v[60:63], v[52:55], v[84:99]
    ds_read_b64_tr_b16 v[32:33], v120 offset:15488
    ds_read_b64_tr_b16 v[34:35], v120 offset:16256
    v_mfma_f32_32x32x16_bf16 v[100:115], v[64:67], v[52:55], v[100:115]
    s_waitcnt vmcnt(3)
    s_mov_b32 s45, 0
g_poll_1:
    v_cmp_eq_u32 vcc, v127, v160
    v_cmp_eq_u32 s[92:93], v155, v160
    s_and_b64 vcc, vcc, s[92:93]
    s_add_u32 s37, s31, s40
    s_cmp_lt_u32 s37, 43
    s_cselect_b32 s58, 1, 0
    s_cmp_lt_u32 s40, 3
    s_cselect_b32 s37, s58, 0
    s_cmp_eq_u32 s37, 0
    s_cbranch_scc1 g_nocs_1
    v_cmp_eq_u32 s[92:93], v157, v160
    s_and_b64 vcc, vcc, s[92:93]
    v_cmp_eq_u32 s[92:93], v159, v160
    s_and_b64 vcc, vcc, s[92:93]
g_nocs_1:
    v_cmp_ne_u32 s[92:93], 0, v160
    s_and_b64 vcc, vcc, s[92:93]
    s_cmp_eq_u64 vcc, -1
    s_cbranch_scc1 g_pollok_1
    s_add_u32 s45, s45, 1
    s_cmp_gt_u32 s45, 20000
    s_cbranch_scc1 g_pollok_1
    s_sleep 1
    buffer_load_dword v160, v165, s[52:55], 0 offen sc1
    buffer_load_dwordx4 v[124:127], v122, s[24:27], 0 offen sc1
    buffer_load_dwordx4 v[152:155], v122, s[24:27], 0 offen offset:16 sc1
    buffer_load_dwordx4 v[156:159], v164, s[24:27], 0 offen sc1
    s_waitcnt vmcnt(0)
    s_branch g_poll_1
g_pollok_1:
    v_readfirstlane_b32 s59, v160
    s_waitcnt vmcnt(11) lgkmcnt(0)
    s_barrier
    v_mfma_f32_32x32x16_bf16 v[68:83], v[8:11], v[4:7], v[68:83]
    ds_read_b128 v[36:39], v118 offset:0
    ds_read_b64_tr_b16 v[40:41], v120 offset:18432
    ds_read_b64_tr_b16 v[42:43], v120 offset:19200
    v_mfma_f32_32x32x16_bf16 v[84:99], v[12:15], v[4:7], v[84:99]
    ds_read_b64_tr_b16 v[44:45], v120 offset:18496
    ds_read_b64_tr_b16 v[46:47], v120 offset:19264
    ds_read_b64_tr_b16 v[48:49], v120 offset:18560
    v_mfma_f32_32x32x16_bf16 v[100:115], v[16:19], v[4:7], v[100:115]
    ds_read_b64_tr_b16 v[50:51], v120 offset:19328
    ds_read_b128 v[52:55], v119 offset:0
    ds_read_b64_tr_b16 v[56:57], v120 offset:21504
    v_mfma_f32_32x32x16_bf16 v[68:83], v[24:27], v[20:23], v[68:83]
    ds_read_b64_tr_b16 v[58:59], v120 offset:22272
    ds_read_b64_tr_b16 v[60:61], v120 offset:21568
    ds_read_b64_tr_b16 v[62:63], v120 offset:22336
    v_mfma_f32_32x32x16_bf16 v[84:99], v[28:31], v[20:23], v[84:99]
    ds_read_b64_tr_b16 v[64:65], v120 offset:21632
    ds_read_b64_tr_b16 v[66:67], v120 offset:22400
    v_mfma_f32_32x32x16_bf16 v[100:115], v[32:35], v[20:23], v[100:115]
    s_cmp_ge_u32 s40, 3
    s_cbranch_scc1 g_noaext_1
    v_mov_b32 v168, v156
    v_mov_b32 v169, v158
    v_mov_b32 v2, v156
    v_mov_b32 v3, v158
    s_nop 1
    v_permlane32_swap_b32 v168, v2
    v_permlane32_swap_b32 v169, v3
    v_add_f32 v168, v168, v2
    v_add_f32 v169, v169, v3
    v_mov_b32 v2, v168
    v_mov_b32 v3, v169
    s_nop 1
    v_permlane16_swap_b32 v168, v2
    v_permlane16_swap_b32 v169, v3
    v_add_f32 v168, v168, v2
    v_add_f32 v169, v169, v3
    v_and_b32 v2, 15, v1
    v_lshlrev_b32 v2, 3, v2
    s_lshl_b32 s37, s40, 7
    s_add_u32 s37, s37, 81152
    v_add_u32 v2, s37, v2
    ds_write_b64 v2, v[168:169]
    v_lshlrev_b32 v3, 2, v162
    v_add_u32 v3, s37, v3
    ds_read_b32 v170, v3
g_noaext_1:
    s_waitcnt vmcnt(1) lgkmcnt(0)
    s_barrier
    v_mfma_f32_32x32x16_bf16 v[68:83], v[40:43], v[36:39], v[68:83]
    ds_read_b128 v[4:7], v116 offset:16384
    ds_read_b64_tr_b16 v[8:9], v120 offset:24576
    ds_read_b64_tr_b16 v[10:11], v120 offset:25344
    v_mfma_f32_32x32x16_bf16 v[84:99], v[44:47], v[36:39], v[84:99]
    ds_read_b64_tr_b16 v[12:13], v120 offset:24640
    ds_read_b64_tr_b16 v[14:15], v120 offset:25408
    ds_read_b64_tr_b16 v[16:17], v120 offset:24704
    v_mfma_f32_32x32x16_bf16 v[100:115], v[48:51], v[36:39], v[100:115]
    ds_read_b64_tr_b16 v[18:19], v120 offset:25472
    ds_read_b128 v[20:23], v117 offset:16384
    ds_read_b64_tr_b16 v[24:25], v120 offset:27648
    v_mfma_f32_32x32x16_bf16 v[68:83], v[56:59], v[52:55], v[68:83]
    ds_read_b64_tr_b16 v[26:27], v120 offset:28416
    ds_read_b64_tr_b16 v[28:29], v120 offset:27712
    ds_read_b64_tr_b16 v[30:31], v120 offset:28480
    v_mfma_f32_32x32x16_bf16 v[84:99], v[60:63], v[52:55], v[84:99]
    ds_read_b64_tr_b16 v[32:33], v120 offset:27776
    ds_read_b64_tr_b16 v[34:35], v120 offset:28544
    v_mfma_f32_32x32x16_bf16 v[100:115], v[64:67], v[52:55], v[100:115]
    s_cmp_ge_u32 s40, 3
    s_cbranch_scc1 g_noaext2_1
    s_mov_b32 s46, 0x05040100
    v_cvt_pk_bf16_f32 v2, v170, v170
    v_lshlrev_b32 v3, 16, v2
    v_sub_f32 v3, v170, v3
    v_cvt_pk_bf16_f32 v3, v3, v3
    v_cndmask_b32 v172, 0, v2, s[62:63]
    v_perm_b32 v175, v161, v3, s46
    v_cndmask_b32 v174, 0, v161, s[62:63]
    v_cndmask_b32 v173, 0, v175, s[62:63]
    v_mov_b32 v175, 0
    s_lshl_b32 s37, s40, 10
    v_add_u32 v2, s37, v123
    ds_write_b128 v2, v[172:175] offset:32768
g_noaext2_1:
    s_waitcnt vmcnt(0) lgkmcnt(0)
    s_barrier
    v_mfma_f32_32x32x16_bf16 v[68:83], v[8:11], v[4:7], v[68:83]
    ds_read_b128 v[36:39], v118 offset:16384
    ds_read_b64_tr_b16 v[40:41], v120 offset:0
    ds_read_b64_tr_b16 v[42:43], v120 offset:768
    v_mfma_f32_32x32x16_bf16 v[84:99], v[12:15], v[4:7], v[84:99]
    ds_read_b64_tr_b16 v[44:45], v120 offset:64
    ds_read_b64_tr_b16 v[46:47], v120 offset:832
    ds_read_b64_tr_b16 v[48:49], v120 offset:128
    v_mfma_f32_32x32x16_bf16 v[100:115], v[16:19], v[4:7], v[100:115]
    ds_read_b64_tr_b16 v[50:51], v120 offset:896
    ds_read_b128 v[52:55], v119 offset:16384
    ds_read_b64_tr_b16 v[56:57], v120 offset:3072
    v_mfma_f32_32x32x16_bf16 v[68:83], v[24:27], v[20:23], v[68:83]
    ds_read_b64_tr_b16 v[58:59], v120 offset:3840
    ds_read_b64_tr_b16 v[60:61], v120 offset:3136
    ds_read_b64_tr_b16 v[62:63], v120 offset:3904
    v_mfma_f32_32x32x16_bf16 v[84:99], v[28:31], v[20:23], v[84:99]
    ds_read_b64_tr_b16 v[64:65], v120 offset:3200
    ds_read_b64_tr_b16 v[66:67], v120 offset:3968
    v_mfma_f32_32x32x16_bf16 v[100:115], v[32:35], v[20:23], v[100:115]
    s_waitcnt lgkmcnt(0)
    v_mfma_f32_32x32x16_bf16 v[68:83], v[40:43], v[36:39], v[68:83]
    v_mfma_f32_32x32x16_bf16 v[84:99], v[44:47], v[36:39], v[84:99]
    v_mfma_f32_32x32x16_bf16 v[100:115], v[48:51], v[36:39], v[100:115]
    v_mfma_f32_32x32x16_bf16 v[68:83], v[56:59], v[52:55], v[68:83]
    v_mfma_f32_32x32x16_bf16 v[84:99], v[60:63], v[52:55], v[84:99]
    v_mfma_f32_32x32x16_bf16 v[100:115], v[64:67], v[52:55], v[100:115]
    s_branch g_p1done
g_v2:
    s_add_u32 m0, s42, 0
    s_add_u32 s48, s38, 0
    buffer_load_dwordx4 v128, s[12:15], s48 offen lds
    s_add_u32 m0, s42, 1024
    s_add_u32 s48, s38, 8192
    buffer_load_dwordx4 v130, s[12:15], s48 offen lds
    s_add_u32 m0, s42, 2048
    s_add_u32 s48, s38, 16384
    buffer_load_dwordx4 v128, s[12:15], s48 offen lds
    s_add_u32 m0, s42, 3072
    s_add_u32 s48, s38, 24576
    buffer_load_dwordx4 v130, s[12:15], s48 offen lds
    s_add_u32 s38, s38, 128
    s_and_b32 s38, s38, 0x3ff
    s_add_u32 m0, s43, 0
    s_mul_i32 s48, s39, 1376
    buffer_load_dwordx4 v129, s[16:19], s48 offen lds
    s_add_u32 m0, s44, 0
    s_add_u32 s39, s39, 64
    buffer_load_dwordx4 v131, s[16:19], s48 offen lds
    s_and_b32 s39, s39, 0x3ff
    s_add_u32 m0, s43, 6144
    s_mul_i32 s48, s39, 1376
    buffer_load_dwordx4 v129, s[16:19], s48 offen lds
    s_add_u32 m0, s44, 6144
    s_add_u32 s39, s39, 64
    buffer_load_dwordx4 v131, s[16:19], s48 offen lds
    s_and_b32 s39, s39, 0x3ff
    s_mov_b32 s20, s8
    s_mov_b32 s21, s9
    s_mov_b32 s22, 0xac0
    s_mov_b32 s23, 0x00020000
    s_mov_b32 s24, s10
    s_mov_b32 s25, s11
    s_mov_b32 s26, 0x1000000
    s_mov_b32 s27, 0x00020000
    s_mov_b32 s52, s34
    s_mov_b32 s53, s35
    s_mov_b32 s54, 0x100
    s_mov_b32 s55, 0x00020000
    v_and_b32 v2, 31, v1
    v_lshrrev_b32 v3, 5, v1
    v_bfe_u32 v12, v2, 1, 3
    v_xor_b32 v3, v3, v12
    v_lshlrev_b32 v3, 4, v3
    v_lshl_add_u32 v116, v2, 7, v3
    s_lshl_b32 s37, s28, 12
    v_add_u32 v116, s37, v116
    v_xor_b32 v117, 32, v116
    v_xor_b32 v118, 64, v116
    v_xor_b32 v119, 96, v116
    v_lshrrev_b32 v2, 4, v1
    v_bfe_u32 v3, v1, 2, 2
    v_and_b32 v12, 3, v1
    v_lshrrev_b32 v13, 1, v2
    v_and_b32 v2, 1, v2
    v_lshl_add_u32 v2, v2, 2, v12
    v_and_b32 v12, 1, v2
    v_lshlrev_b32 v12, 4, v12
    v_lshrrev_b32 v2, 1, v2
    v_lshl_add_u32 v12, v2, 2, v12
    v_lshl_add_u32 v13, v13, 3, v3
    v_mul_u32_u24 v13, 192, v13
    v_lshl_add_u32 v120, v12, 1, v13
    v_add_u32 v120, 49152, v120
    v_bfe_u32 v2, v1, 4, 1
    v_lshlrev_b32 v2, 10, v2
    v_and_b32 v3, 15, v1
    v_lshl_add_u32 v2, v3, 4, v2
    v_lshrrev_b32 v3, 5, v1
    v_lshl_add_u32 v121, v3, 9, v2
    s_lshl_b32 s60, s29, 1
    s_lshr_b32 s47, s28, 1
    s_add_u32 s60, s60, s47
    s_mul_i32 s60, s60, 176128
    s_and_b32 s47, s28, 1
    s_lshl_b32 s47, s47, 11
    s_add_u32 s60, s60, s47
    s_lshl_b32 s47, s31, 12
    s_add_u32 s60, s60, s47
    s_lshl_b32 s37, s29, 7
    s_lshl_b32 s58, s28, 5
    s_add_u32 s37, s37, s58
    v_and_b32 v2, 31, v1
    v_add_u32 v2, s37, v2
    v_lshlrev_b32 v122, 5, v2
    v_add_u32 v122, 14680064, v122
    v_lshlrev_b32 v123, 4, v1
    v_cmp_gt_u32 s[62:63], 32, v1
    s_add_u32 s37, s31, s40
    s_lshl_b32 s37, s37, 10
    s_add_u32 s37, s37, 14745600
    v_add_u32 v164, s37, v123
    v_mov_b32 v165, 0
    v_bfe_u32 v2, v1, 2, 1
    v_lshlrev_b32 v2, 4, v2
    v_bfe_u32 v3, v1, 3, 2
    v_lshl_add_u32 v2, v3, 2, v2
    v_and_b32 v3, 3, v1
    v_add_u32 v162, v2, v3
    s_lshl_b32 s37, s40, 6
    s_add_u32 s37, s37, s36
    v_lshlrev_b32 v2, 1, v162
    v_add_u32 v163, s37, v2
    v_mov_b32 v68, 0
    v_mov_b32 v69, 0
    v_mov_b32 v70, 0
    v_mov_b32 v71, 0
    v_mov_b32 v72, 0
    v_mov_b32 v73, 0
    v_mov_b32 v74, 0
    v_mov_b32 v75, 0
    v_mov_b32 v76, 0
    v_mov_b32 v77, 0
    v_mov_b32 v78, 0
    v_mov_b32 v79, 0
    v_mov_b32 v80, 0
    v_mov_b32 v81, 0
    v_mov_b32 v82, 0
    v_mov_b32 v83, 0
    v_mov_b32 v84, 0
    v_mov_b32 v85, 0
    v_mov_b32 v86, 0
    v_mov_b32 v87, 0
    v_mov_b32 v88, 0
    v_mov_b32 v89, 0
    v_mov_b32 v90, 0
    v_mov_b32 v91, 0
    v_mov_b32 v92, 0
    v_mov_b32 v93, 0
    v_mov_b32 v94, 0
    v_mov_b32 v95, 0
    v_mov_b32 v96, 0
    v_mov_b32 v97, 0
    v_mov_b32 v98, 0
    v_mov_b32 v99, 0
    v_mov_b32 v100, 0
    v_mov_b32 v101, 0
    v_mov_b32 v102, 0
    v_mov_b32 v103, 0
    v_mov_b32 v104, 0
    v_mov_b32 v105, 0
    v_mov_b32 v106, 0
    v_mov_b32 v107, 0
    v_mov_b32 v108, 0
    v_mov_b32 v109, 0
    v_mov_b32 v110, 0
    v_mov_b32 v111, 0
    v_mov_b32 v112, 0
    v_mov_b32 v113, 0
    v_mov_b32 v114, 0
    v_mov_b32 v115, 0
    s_waitcnt vmcnt(2) lgkmcnt(0)
    s_barrier
    ds_read_b128 v[4:7], v116 offset:0
    ds_read_b64_tr_b16 v[8:9], v120 offset:0
    ds_read_b64_tr_b16 v[10:11], v120 offset:768
    ds_read_b64_tr_b16 v[12:13], v120 offset:64
    ds_read_b64_tr_b16 v[14:15], v120 offset:832
    ds_read_b64_tr_b16 v[16:17], v120 offset:128
    ds_read_b64_tr_b16 v[18:19], v120 offset:896
    ds_read_b128 v[20:23], v117 offset:0
    ds_read_b64_tr_b16 v[24:25], v120 offset:3072
    ds_read_b64_tr_b16 v[26:27], v120 offset:3840
    ds_read_b64_tr_b16 v[28:29], v120 offset:3136
    ds_read_b64_tr_b16 v[30:31], v120 offset:3904
    ds_read_b64_tr_b16 v[32:33], v120 offset:3200
    ds_read_b64_tr_b16 v[34:35], v120 offset:3968
    s_add_u32 m0, s42, 16384
    s_add_u32 s48, s38, 0
    buffer_load_dwordx4 v128, s[12:15], s48 offen lds
    s_add_u32 m0, s42, 17408
    s_add_u32 s48, s38, 8192
    buffer_load_dwordx4 v130, s[12:15], s48 offen lds
    s_add_u32 m0, s42, 18432
    s_add_u32 s48, s38, 16384
    buffer_load_dwordx4 v128, s[12:15], s48 offen lds
    s_add_u32 m0, s42, 19456
    s_add_u32 s48, s38, 24576
    buffer_load_dwordx4 v130, s[12:15], s48 offen lds
    s_add_u32 s38, s38, 128
    s_and_b32 s38, s38, 0x3ff
    s_add_u32 m0, s43, 12288
    s_mul_i32 s48, s39, 1376
    buffer_load_dwordx4 v129, s[16:19], s48 offen lds
    s_add_u32 m0, s44, 12288
    s_add_u32 s39, s39, 64
    buffer_load_dwordx4 v131, s[16:19], s48 offen lds
    s_and_b32 s39, s39, 0x3ff
    s_add_u32 m0, s43, 18432
    s_mul_i32 s48, s39, 1376
    buffer_load_dwordx4 v129, s[16:19], s48 offen lds
    s_add_u32 m0, s44, 18432
    s_add_u32 s39, s39, 64
    buffer_load_dwordx4 v131, s[16:19], s48 offen lds
    s_and_b32 s39, s39, 0x3ff
    s_waitcnt vmcnt(8) lgkmcnt(0)
    s_barrier
    v_mfma_f32_32x32x16_bf16 v[68:83], v[8:11], v[4:7], v[68:83]
    ds_read_b128 v[36:39], v118 offset:0
    ds_read_b64_tr_b16 v[40:41], v120 offset:6144
    ds_read_b64_tr_b16 v[42:43], v120 offset:6912
    s_add_u32 m0, s42, 32768
    s_add_u32 s48, s38, 0
    buffer_load_dwordx4 v128, s[12:15], s48 offen lds
    s_add_u32 m0, s42, 33792
    s_add_u32 s48, s38, 8192
    buffer_load_dwordx4 v130, s[12:15], s48 offen lds
    v_mfma_f32_32x32x16_bf16 v[84:99], v[12:15], v[4:7], v[84:99]
    ds_read_b64_tr_b16 v[44:45], v120 offset:6208
    ds_read_b64_tr_b16 v[46:47], v120 offset:6976
    ds_read_b64_tr_b16 v[48:49], v120 offset:6272
    s_add_u32 m0, s43, 24576
    s_mul_i32 s48, s39, 1376
    buffer_load_dwordx4 v129, s[16:19], s48 offen lds
    v_mfma_f32_32x32x16_bf16 v[100:115], v[16:19], v[4:7], v[100:115]
    ds_read_b64_tr_b16 v[50:51], v120 offset:7040
    ds_read_b128 v[52:55], v119 offset:0
    ds_read_b64_tr_b16 v[56:57], v120 offset:9216
    s_add_u32 m0, s44, 24576
    s_add_u32 s39, s39, 64
    buffer_load_dwordx4 v131, s[16:19], s48 offen lds
    v_mfma_f32_32x32x16_bf16 v[68:83], v[24:27], v[20:23], v[68:83]
    ds_read_b64_tr_b16 v[58:59], v120 offset:9984
    ds_read_b64_tr_b16 v[60:61], v120 offset:9280
    ds_read_b64_tr_b16 v[62:63], v120 offset:10048
    s_and_b32 s39, s39, 0x3ff
    s_add_u32 m0, s42, 34816
    s_add_u32 s48, s38, 16384
    buffer_load_dwordx4 v128, s[12:15], s48 offen lds
    s_add_u32 m0, s42, 35840
    s_add_u32 s48, s38, 24576
    buffer_load_dwordx4 v130, s[12:15], s48 offen lds
    v_mfma_f32_32x32x16_bf16 v[84:99], v[28:31], v[20:23], v[84:99]
    ds_read_b64_tr_b16 v[64:65], v120 offset:9344
    ds_read_b64_tr_b16 v[66:67], v120 offset:10112
    s_add_u32 s38, s38, 128
    s_and_b32 s38, s38, 0x3ff
    s_add_u32 m0, s43, 0
    s_mul_i32 s48, s39, 1376
    buffer_load_dwordx4 v129, s[16:19], s48 offen lds
    v_mfma_f32_32x32x16_bf16 v[100:115], v[32:35], v[20:23], v[100:115]
    s_add_u32 m0, s44, 0
    s_add_u32 s39, s39, 64
    buffer_load_dwordx4 v131, s[16:19], s48 offen lds
    s_and_b32 s39, s39, 0x3ff
    s_waitcnt vmcnt(10) lgkmcnt(0)
    s_barrier
    v_mfma_f32_32x32x16_bf16 v[68:83], v[40:43], v[36:39], v[68:83]
    ds_read_b128 v[4:7], v116 offset:16384
    ds_read_b64_tr_b16 v[8:9], v120 offset:12288
    ds_read_b64_tr_b16 v[10:11], v120 offset:13056
    s_add_u32 m0, s42, 0
    s_add_u32 s48, s38, 0
    buffer_load_dwordx4 v128, s[12:15], s48 offen lds
    v_mfma_f32_32x32x16_bf16 v[84:99], v[44:47], v[36:39], v[84:99]
    ds_read_b64_tr_b16 v[12:13], v120 offset:12352
    ds_read_b64_tr_b16 v[14:15], v120 offset:13120
    ds_read_b64_tr_b16 v[16:17], v120 offset:12416
    s_add_u32 m0, s42, 1024
    s_add_u32 s48, s38, 8192
    buffer_load_dwordx4 v130, s[12:15], s48 offen lds
    v_mfma_f32_32x32x16_bf16 v[100:115], v[48:51], v[36:39], v[100:115]
    ds_read_b64_tr_b16 v[18:19], v120 offset:13184
    ds_read_b128 v[20:23], v117 offset:16384
    ds_read_b64_tr_b16 v[24:25], v120 offset:15360
    v_mfma_f32_32x32x16_bf16 v[68:83], v[56:59], v[52:55], v[68:83]
    ds_read_b64_tr_b16 v[26:27], v120 offset:16128
    ds_read_b64_tr_b16 v[28:29], v120 offset:15424
    ds_read_b64_tr_b16 v[30:31], v120 offset:16192
    s_add_u32 m0, s43, 6144
    s_mul_i32 s48, s39, 1376
    buffer_load_dwordx4 v129, s[16:19], s48 offen lds
    v_mfma_f32_32x32x16_bf16 v[84:99], v[60:63], v[52:55], v[84:99]
    ds_read_b64_tr_b16 v[32:33], v120 offset:15488
    ds_read_b64_tr_b16 v[34:35], v120 offset:16256
    s_add_u32 m0, s44, 6144
    s_add_u32 s39, s39, 64
    buffer_load_dwordx4 v131, s[16:19], s48 offen lds
    s_and_b32 s39, s39, 0x3ff
    v_mfma_f32_32x32x16_bf16 v[100:115], v[64:67], v[52:55], v[100:115]
    s_waitcnt vmcnt(12) lgkmcnt(0)
    s_barrier
    v_mfma_f32_32x32x16_bf16 v[68:83], v[8:11], v[4:7], v[68:83]
    ds_read_b128 v[36:39], v118 offset:16384
    ds_read_b64_tr_b16 v[40:41], v120 offset:18432
    ds_read_b64_tr_b16 v[42:43], v120 offset:19200
    s_add_u32 m0, s42, 2048
    s_add_u32 s48, s38, 16384
    buffer_load_dwordx4 v128, s[12:15], s48 offen lds
    v_mfma_f32_32x32x16_bf16 v[84:99], v[12:15], v[4:7], v[84:99]
    ds_read_b64_tr_b16 v[44:45], v120 offset:18496
    ds_read_b64_tr_b16 v[46:47], v120 offset:19264
    ds_read_b64_tr_b16 v[48:49], v120 offset:18560
    s_add_u32 m0, s42, 3072
    s_add_u32 s48, s38, 24576
    buffer_load_dwordx4 v130, s[12:15], s48 offen lds
    v_mfma_f32_32x32x16_bf16 v[100:115], v[16:19], v[4:7], v[100:115]
    ds_read_b64_tr_b16 v[50:51], v120 offset:19328
    ds_read_b128 v[52:55], v119 offset:16384
    ds_read_b64_tr_b16 v[56:57], v120 offset:21504
    v_mfma_f32_32x32x16_bf16 v[68:83], v[24:27], v[20:23], v[68:83]
    ds_read_b64_tr_b16 v[58:59], v120 offset:22272
    ds_read_b64_tr_b16 v[60:61], v120 offset:21568
    ds_read_b64_tr_b16 v[62:63], v120 offset:22336
    s_add_u32 s38, s38, 128
    s_and_b32 s38, s38, 0x3ff
    s_add_u32 m0, s43, 12288
    s_mul_i32 s48, s39, 1376
    buffer_load_dwordx4 v129, s[16:19], s48 offen lds
    v_mfma_f32_32x32x16_bf16 v[84:99], v[28:31], v[20:23], v[84:99]
    ds_read_b64_tr_b16 v[64:65], v120 offset:21632
    ds_read_b64_tr_b16 v[66:67], v120 offset:22400
    s_add_u32 m0, s44, 12288
    s_add_u32 s39, s39, 64
    buffer_load_dwordx4 v131, s[16:19], s48 offen lds
    s_and_b32 s39, s39, 0x3ff
    v_mfma_f32_32x32x16_bf16 v[100:115], v[32:35], v[20:23], v[100:115]
    s_waitcnt vmcnt(10) lgkmcnt(0)
    s_barrier
    v_mfma_f32_32x32x16_bf16 v[68:83], v[40:43], v[36:39], v[68:83]
    ds_read_b128 v[4:7], v116 offset:32768
    ds_read_b64_tr_b16 v[8:9], v120 offset:24576
    ds_read_b64_tr_b16 v[10:11], v120 offset:25344
    s_add_u32 m0, s42, 16384
    s_add_u32 s48, s38, 0
    buffer_load_dwordx4 v128, s[12:15], s48 offen lds
    v_mfma_f32_32x32x16_bf16 v[84:99], v[44:47], v[36:39], v[84:99]
    ds_read_b64_tr_b16 v[12:13], v120 offset:24640
    ds_read_b64_tr_b16 v[14:15], v120 offset:25408
    ds_read_b64_tr_b16 v[16:17], v120 offset:24704
    s_add_u32 m0, s42, 17408
    s_add_u32 s48, s38, 8192
    buffer_load_dwordx4 v130, s[12:15], s48 offen lds
    v_mfma_f32_32x32x16_bf16 v[100:115], v[48:51], v[36:39], v[100:115]
    ds_read_b64_tr_b16 v[18:19], v120 offset:25472
    ds_read_b128 v[20:23], v117 offset:32768
    ds_read_b64_tr_b16 v[24:25], v120 offset:27648
    v_mfma_f32_32x32x16_bf16 v[68:83], v[56:59], v[52:55], v[68:83]
    ds_read_b64_tr_b16 v[26:27], v120 offset:28416
    ds_read_b64_tr_b16 v[28:29], v120 offset:27712
    ds_read_b64_tr_b16 v[30:31], v120 offset:28480
    s_add_u32 m0, s43, 18432
    s_mul_i32 s48, s39, 1376
    buffer_load_dwordx4 v129, s[16:19], s48 offen lds
    v_mfma_f32_32x32x16_bf16 v[84:99], v[60:63], v[52:55], v[84:99]
    ds_read_b64_tr_b16 v[32:33], v120 offset:27776
    ds_read_b64_tr_b16 v[34:35], v120 offset:28544
    s_add_u32 m0, s44, 18432
    s_add_u32 s39, s39, 64
    buffer_load_dwordx4 v131, s[16:19], s48 offen lds
    s_and_b32 s39, s39, 0x3ff
    v_mfma_f32_32x32x16_bf16 v[100:115], v[64:67], v[52:55], v[100:115]
    s_waitcnt vmcnt(12) lgkmcnt(0)
    s_barrier
    v_mfma_f32_32x32x16_bf16 v[68:83], v[8:11], v[4:7], v[68:83]
    ds_read_b128 v[36:39], v118 offset:32768
    ds_read_b64_tr_b16 v[40:41], v120 offset:0
    ds_read_b64_tr_b16 v[42:43], v120 offset:768
    s_add_u32 m0, s42, 18432
    s_add_u32 s48, s38, 16384
    buffer_load_dwordx4 v128, s[12:15], s48 offen lds
    v_mfma_f32_32x32x16_bf16 v[84:99], v[12:15], v[4:7], v[84:99]
    ds_read_b64_tr_b16 v[44:45], v120 offset:64
    ds_read_b64_tr_b16 v[46:47], v120 offset:832
    ds_read_b64_tr_b16 v[48:49], v120 offset:128
    s_add_u32 m0, s42, 19456
    s_add_u32 s48, s38, 24576
    buffer_load_dwordx4 v130, s[12:15], s48 offen lds
    v_mfma_f32_32x32x16_bf16 v[100:115], v[16:19], v[4:7], v[100:115]
    ds_read_b64_tr_b16 v[50:51], v120 offset:896
    ds_read_b128 v[52:55], v119 offset:32768
    ds_read_b64_tr_b16 v[56:57], v120 offset:3072
    v_mfma_f32_32x32x16_bf16 v[68:83], v[24:27], v[20:23], v[68:83]
    ds_read_b64_tr_b16 v[58:59], v120 offset:3840
    ds_read_b64_tr_b16 v[60:61], v120 offset:3136
    ds_read_b64_tr_b16 v[62:63], v120 offset:3904
    s_add_u32 s38, s38, 128
    s_and_b32 s38, s38, 0x3ff
    s_add_u32 m0, s43, 24576
    s_mul_i32 s48, s39, 1376
    buffer_load_dwordx4 v129, s[16:19], s48 offen lds
    v_mfma_f32_32x32x16_bf16 v[84:99], v[28:31], v[20:23], v[84:99]
    ds_read_b64_tr_b16 v[64:65], v120 offset:3200
    ds_read_b64_tr_b16 v[66:67], v120 offset:3968
    s_add_u32 m0, s44, 24576
    s_add_u32 s39, s39, 64
    buffer_load_dwordx4 v131, s[16:19], s48 offen lds
    s_and_b32 s39, s39, 0x3ff
    v_mfma_f32_32x32x16_bf16 v[100:115], v[32:35], v[20:23], v[100:115]
    s_waitcnt vmcnt(10) lgkmcnt(0)
    s_barrier
    v_mfma_f32_32x32x16_bf16 v[68:83], v[40:43], v[36:39], v[68:83]
    ds_read_b128 v[4:7], v116 offset:0
    ds_read_b64_tr_b16 v[8:9], v120 offset:6144
    ds_read_b64_tr_b16 v[10:11], v120 offset:6912
    s_add_u32 m0, s42, 32768
    s_add_u32 s48, s38, 0
    buffer_load_dwordx4 v128, s[12:15], s48 offen lds
    v_mfma_f32_32x32x16_bf16 v[84:99], v[44:47], v[36:39], v[84:99]
    ds_read_b64_tr_b16 v[12:13], v120 offset:6208
    ds_read_b64_tr_b16 v[14:15], v120 offset:6976
    ds_read_b64_tr_b16 v[16:17], v120 offset:6272
    s_add_u32 m0, s42, 33792
    s_add_u32 s48, s38, 8192
    buffer_load_dwordx4 v130, s[12:15], s48 offen lds
    v_mfma_f32_32x32x16_bf16 v[100:115], v[48:51], v[36:39], v[100:115]
    ds_read_b64_tr_b16 v[18:19], v120 offset:7040
    ds_read_b128 v[20:23], v117 offset:0
    ds_read_b64_tr_b16 v[24:25], v120 offset:9216
    v_mfma_f32_32x32x16_bf16 v[68:83], v[56:59], v[52:55], v[68:83]
    ds_read_b64_tr_b16 v[26:27], v120 offset:9984
    ds_read_b64_tr_b16 v[28:29], v120 offset:9280
    ds_read_b64_tr_b16 v[30:31], v120 offset:10048
    s_add_u32 m0, s43, 0
    s_mul_i32 s48, s39, 1376
    buffer_load_dwordx4 v129, s[16:19], s48 offen lds
    v_mfma_f32_32x32x16_bf16 v[84:99], v[60:63], v[52:55], v[84:99]
    ds_read_b64_tr_b16 v[32:33], v120 offset:9344
    ds_read_b64_tr_b16 v[34:35], v120 offset:10112
    s_add_u32 m0, s44, 0
    s_add_u32 s39, s39, 64
    buffer_load_dwordx4 v131, s[16:19], s48 offen lds
    s_and_b32 s39, s39, 0x3ff
    v_mfma_f32_32x32x16_bf16 v[100:115], v[64:67], v[52:55], v[100:115]
    s_waitcnt vmcnt(12) lgkmcnt(0)
    s_barrier
    v_mfma_f32_32x32x16_bf16 v[68:83], v[8:11], v[4:7], v[68:83]
    ds_read_b128 v[36:39], v118 offset:0
    ds_read_b64_tr_b16 v[40:41], v120 offset:12288
    ds_read_b64_tr_b16 v[42:43], v120 offset:13056
    s_add_u32 m0, s42, 34816
    s_add_u32 s48, s38, 16384
    buffer_load_dwordx4 v128, s[12:15], s48 offen lds
    v_mfma_f32_32x32x16_bf16 v[84:99], v[12:15], v[4:7], v[84:99]
    ds_read_b64_tr_b16 v[44:45], v120 offset:12352
    ds_read_b64_tr_b16 v[46:47], v120 offset:13120
    ds_read_b64_tr_b16 v[48:49], v120 offset:12416
    s_add_u32 m0, s42, 35840
    s_add_u32 s48, s38, 24576
    buffer_load_dwordx4 v130, s[12:15], s48 offen lds
    v_mfma_f32_32x32x16_bf16 v[100:115], v[16:19], v[4:7], v[100:115]
    ds_read_b64_tr_b16 v[50:51], v120 offset:13184
    ds_read_b128 v[52:55], v119 offset:0
    ds_read_b64_tr_b16 v[56:57], v120 offset:15360
    v_mfma_f32_32x32x16_bf16 v[68:83], v[24:27], v[20:23], v[68:83]
    ds_read_b64_tr_b16 v[58:59], v120 offset:16128
    ds_read_b64_tr_b16 v[60:61], v120 offset:15424
    ds_read_b64_tr_b16 v[62:63], v120 offset:16192
    s_add_u32 s38, s38, 128
    s_and_b32 s38, s38, 0x3ff
    s_add_u32 m0, s43, 6144
    s_mul_i32 s48, s39, 1376
    buffer_load_dwordx4 v129, s[16:19], s48 offen lds
    v_mfma_f32_32x32x16_bf16 v[84:99], v[28:31], v[20:23], v[84:99]
    ds_read_b64_tr_b16 v[64:65], v120 offset:15488
    ds_read_b64_tr_b16 v[66:67], v120 offset:16256
    s_add_u32 m0, s44, 6144
    s_add_u32 s39, s39, 64
    buffer_load_dwordx4 v131, s[16:19], s48 offen lds
    s_and_b32 s39, s39, 0x3ff
    v_mfma_f32_32x32x16_bf16 v[100:115], v[32:35], v[20:23], v[100:115]
    s_waitcnt vmcnt(10) lgkmcnt(0)
    s_barrier
    v_mfma_f32_32x32x16_bf16 v[68:83], v[40:43], v[36:39], v[68:83]
    ds_read_b128 v[4:7], v116 offset:16384
    ds_read_b64_tr_b16 v[8:9], v120 offset:18432
    ds_read_b64_tr_b16 v[10:11], v120 offset:19200
    s_add_u32 m0, s42, 0
    s_add_u32 s48, s38, 0
    buffer_load_dwordx4 v128, s[12:15], s48 offen lds
    v_mfma_f32_32x32x16_bf16 v[84:99], v[44:47], v[36:39], v[84:99]
    ds_read_b64_tr_b16 v[12:13], v120 offset:18496
    ds_read_b64_tr_b16 v[14:15], v120 offset:19264
    ds_read_b64_tr_b16 v[16:17], v120 offset:18560
    s_add_u32 m0, s42, 1024
    s_add_u32 s48, s38, 8192
    buffer_load_dwordx4 v130, s[12:15], s48 offen lds
    v_mfma_f32_32x32x16_bf16 v[100:115], v[48:51], v[36:39], v[100:115]
    ds_read_b64_tr_b16 v[18:19], v120 offset:19328
    ds_read_b128 v[20:23], v117 offset:16384
    ds_read_b64_tr_b16 v[24:25], v120 offset:21504
    v_mfma_f32_32x32x16_bf16 v[68:83], v[56:59], v[52:55], v[68:83]
    ds_read_b64_tr_b16 v[26:27], v120 offset:22272
    ds_read_b64_tr_b16 v[28:29], v120 offset:21568
    ds_read_b64_tr_b16 v[30:31], v120 offset:22336
    s_add_u32 m0, s43, 12288
    s_mul_i32 s48, s39, 1376
    buffer_load_dwordx4 v129, s[16:19], s48 offen lds
    v_mfma_f32_32x32x16_bf16 v[84:99], v[60:63], v[52:55], v[84:99]
    ds_read_b64_tr_b16 v[32:33], v120 offset:21632
    ds_read_b64_tr_b16 v[34:35], v120 offset:22400
    s_add_u32 m0, s44, 12288
    s_add_u32 s39, s39, 64
    buffer_load_dwordx4 v131, s[16:19], s48 offen lds
    s_and_b32 s39, s39, 0x3ff
    v_mfma_f32_32x32x16_bf16 v[100:115], v[64:67], v[52:55], v[100:115]
    s_waitcnt vmcnt(12) lgkmcnt(0)
    s_barrier
    v_mfma_f32_32x32x16_bf16 v[68:83], v[8:11], v[4:7], v[68:83]
    ds_read_b128 v[36:39], v118 offset:16384
    ds_read_b64_tr_b16 v[40:41], v120 offset:24576
    ds_read_b64_tr_b16 v[42:43], v120 offset:25344
    s_add_u32 m0, s42, 2048
    s_add_u32 s48, s38, 16384
    buffer_load_dwordx4 v128, s[12:15], s48 offen lds
    v_mfma_f32_32x32x16_bf16 v[84:99], v[12:15], v[4:7], v[84:99]
    ds_read_b64_tr_b16 v[44:45], v120 offset:24640
    ds_read_b64_tr_b16 v[46:47], v120 offset:25408
    ds_read_b64_tr_b16 v[48:49], v120 offset:24704
    s_add_u32 m0, s42, 3072
    s_add_u32 s48, s38, 24576
    buffer_load_dwordx4 v130, s[12:15], s48 offen lds
    v_mfma_f32_32x32x16_bf16 v[100:115], v[16:19], v[4:7], v[100:115]
    ds_read_b64_tr_b16 v[50:51], v120 offset:25472
    ds_read_b128 v[52:55], v119 offset:16384
    ds_read_b64_tr_b16 v[56:57], v120 offset:27648
    v_mfma_f32_32x32x16_bf16 v[68:83], v[24:27], v[20:23], v[68:83]
    ds_read_b64_tr_b16 v[58:59], v120 offset:28416
    ds_read_b64_tr_b16 v[60:61], v120 offset:27712
    ds_read_b64_tr_b16 v[62:63], v120 offset:28480
    s_add_u32 s38, s38, 128
    s_and_b32 s38, s38, 0x3ff
    s_add_u32 m0, s43, 18432
    s_mul_i32 s48, s39, 1376
    buffer_load_dwordx4 v129, s[16:19], s48 offen lds
    v_mfma_f32_32x32x16_bf16 v[84:99], v[28:31], v[20:23], v[84:99]
    ds_read_b64_tr_b16 v[64:65], v120 offset:27776
    ds_read_b64_tr_b16 v[66:67], v120 offset:28544
    s_add_u32 m0, s44, 18432
    s_add_u32 s39, s39, 64
    buffer_load_dwordx4 v131, s[16:19], s48 offen lds
    s_and_b32 s39, s39, 0x3ff
    v_mfma_f32_32x32x16_bf16 v[100:115], v[32:35], v[20:23], v[100:115]
    s_waitcnt vmcnt(10) lgkmcnt(0)
    s_barrier
    v_mfma_f32_32x32x16_bf16 v[68:83], v[40:43], v[36:39], v[68:83]
    ds_read_b128 v[4:7], v116 offset:32768
    ds_read_b64_tr_b16 v[8:9], v120 offset:0
    ds_read_b64_tr_b16 v[10:11], v120 offset:768
    s_add_u32 m0, s42, 16384
    s_add_u32 s48, s38, 0
    buffer_load_dwordx4 v128, s[12:15], s48 offen lds
    v_mfma_f32_32x32x16_bf16 v[84:99], v[44:47], v[36:39], v[84:99]
    ds_read_b64_tr_b16 v[12:13], v120 offset:64
    ds_read_b64_tr_b16 v[14:15], v120 offset:832
    ds_read_b64_tr_b16 v[16:17], v120 offset:128
    s_add_u32 m0, s42, 17408
    s_add_u32 s48, s38, 8192
    buffer_load_dwordx4 v130, s[12:15], s48 offen lds
    v_mfma_f32_32x32x16_bf16 v[100:115], v[48:51], v[36:39], v[100:115]
    ds_read_b64_tr_b16 v[18:19], v120 offset:896
    ds_read_b128 v[20:23], v117 offset:32768
    ds_read_b64_tr_b16 v[24:25], v120 offset:3072
    v_mfma_f32_32x32x16_bf16 v[68:83], v[56:59], v[52:55], v[68:83]
    ds_read_b64_tr_b16 v[26:27], v120 offset:3840
    ds_read_b64_tr_b16 v[28:29], v120 offset:3136
    ds_read_b64_tr_b16 v[30:31], v120 offset:3904
    s_add_u32 m0, s43, 24576
    s_mul_i32 s48, s39, 1376
    buffer_load_dwordx4 v129, s[16:19], s48 offen lds
    v_mfma_f32_32x32x16_bf16 v[84:99], v[60:63], v[52:55], v[84:99]
    ds_read_b64_tr_b16 v[32:33], v120 offset:3200
    ds_read_b64_tr_b16 v[34:35], v120 offset:3968
    s_add_u32 m0, s44, 24576
    s_add_u32 s39, s39, 64
    buffer_load_dwordx4 v131, s[16:19], s48 offen lds
    s_and_b32 s39, s39, 0x3ff
    v_mfma_f32_32x32x16_bf16 v[100:115], v[64:67], v[52:55], v[100:115]
    buffer_load_ushort v161, v163, s[20:23], 0 offen
    buffer_load_dword v160, v165, s[52:55], 0 offen sc1
    buffer_load_dwordx4 v[124:127], v122, s[24:27], 0 offen sc1
    buffer_load_dwordx4 v[152:155], v122, s[24:27], 0 offen offset:16 sc1
    buffer_load_dwordx4 v[156:159], v164, s[24:27], 0 offen sc1
    s_waitcnt vmcnt(17) lgkmcnt(0)
    s_barrier
    v_mfma_f32_32x32x16_bf16 v[68:83], v[8:11], v[4:7], v[68:83]
    ds_read_b128 v[36:39], v118 offset:32768
    ds_read_b64_tr_b16 v[40:41], v120 offset:6144
    ds_read_b64_tr_b16 v[42:43], v120 offset:6912
    s_add_u32 m0, s42, 18432
    s_add_u32 s48, s38, 16384
    buffer_load_dwordx4 v128, s[12:15], s48 offen lds
    v_mfma_f32_32x32x16_bf16 v[84:99], v[12:15], v[4:7], v[84:99]
    ds_read_b64_tr_b16 v[44:45], v120 offset:6208
    ds_read_b64_tr_b16 v[46:47], v120 offset:6976
    ds_read_b64_tr_b16 v[48:49], v120 offset:6272
    s_add_u32 m0, s42, 19456
    s_add_u32 s48, s38, 24576
    buffer_load_dwordx4 v130, s[12:15], s48 offen lds
    v_mfma_f32_32x32x16_bf16 v[100:115], v[16:19], v[4:7], v[100:115]
    ds_read_b64_tr_b16 v[50:51], v120 offset:7040
    ds_read_b128 v[52:55], v119 offset:32768
    ds_read_b64_tr_b16 v[56:57], v120 offset:9216
    v_mfma_f32_32x32x16_bf16 v[68:83], v[24:27], v[20:23], v[68:83]
    ds_read_b64_tr_b16 v[58:59], v120 offset:9984
    ds_read_b64_tr_b16 v[60:61], v120 offset:9280
    ds_read_b64_tr_b16 v[62:63], v120 offset:10048
    s_add_u32 s38, s38, 128
    s_and_b32 s38, s38, 0x3ff
    s_add_u32 m0, s43, 0
    s_mul_i32 s48, s39, 1376
    buffer_load_dwordx4 v129, s[16:19], s48 offen lds
    v_mfma_f32_32x32x16_bf16 v[84:99], v[28:31], v[20:23], v[84:99]
    ds_read_b64_tr_b16 v[64:65], v120 offset:9344
    ds_read_b64_tr_b16 v[66:67], v120 offset:10112
    s_add_u32 m0, s44, 0
    s_add_u32 s39, s39, 64
    buffer_load_dwordx4 v131, s[16:19], s48 offen lds
    s_and_b32 s39, s39, 0x3ff
    v_mfma_f32_32x32x16_bf16 v[100:115], v[32:35], v[20:23], v[100:115]
    s_waitcnt vmcnt(15) lgkmcnt(0)
    s_barrier
    v_mfma_f32_32x32x16_bf16 v[68:83], v[40:43], v[36:39], v[68:83]
    ds_read_b128 v[4:7], v116 offset:0
    ds_read_b64_tr_b16 v[8:9], v120 offset:12288
    ds_read_b64_tr_b16 v[10:11], v120 offset:13056
    v_mfma_f32_32x32x16_bf16 v[84:99], v[44:47], v[36:39], v[84:99]
    ds_read_b64_tr_b16 v[12:13], v120 offset:12352
    ds_read_b64_tr_b16 v[14:15], v120 offset:13120
    ds_read_b64_tr_b16 v[16:17], v120 offset:12416
    v_mfma_f32_32x32x16_bf16 v[100:115], v[48:51], v[36:39], v[100:115]
    ds_read_b64_tr_b16 v[18:19], v120 offset:13184
    ds_read_b128 v[20:23], v117 offset:0
    ds_read_b64_tr_b16 v[24:25], v120 offset:15360
    v_mfma_f32_32x32x16_bf16 v[68:83], v[56:59], v[52:55], v[68:83]
    ds_read_b64_tr_b16 v[26:27], v120 offset:16128
    ds_read_b64_tr_b16 v[28:29], v120 offset:15424
    ds_read_b64_tr_b16 v[30:31], v120 offset:16192
    v_mfma_f32_32x32x16_bf16 v[84:99], v[60:63], v[52:55], v[84:99]
    ds_read_b64_tr_b16 v[32:33], v120 offset:15488
    ds_read_b64_tr_b16 v[34:35], v120 offset:16256
    v_mfma_f32_32x32x16_bf16 v[100:115], v[64:67], v[52:55], v[100:115]
    s_waitcnt vmcnt(4)
    s_mov_b32 s45, 0
g_poll_2:
    v_cmp_eq_u32 vcc, v127, v160
    v_cmp_eq_u32 s[92:93], v155, v160
    s_and_b64 vcc, vcc, s[92:93]
    s_add_u32 s37, s31, s40
    s_cmp_lt_u32 s37, 43
    s_cselect_b32 s58, 1, 0
    s_cmp_lt_u32 s40, 3
    s_cselect_b32 s37, s58, 0
    s_cmp_eq_u32 s37, 0
    s_cbranch_scc1 g_nocs_2
    v_cmp_eq_u32 s[92:93], v157, v160
    s_and_b64 vcc, vcc, s[92:93]
    v_cmp_eq_u32 s[92:93], v159, v160
    s_and_b64 vcc, vcc, s[92:93]
g_nocs_2:
    v_cmp_ne_u32 s[92:93], 0, v160
    s_and_b64 vcc, vcc, s[92:93]
    s_cmp_eq_u64 vcc, -1
    s_cbranch_scc1 g_pollok_2
    s_add_u32 s45, s45, 1
    s_cmp_gt_u32 s45, 20000
    s_cbranch_scc1 g_pollok_2
    s_sleep 1
    buffer_load_dword v160, v165, s[52:55], 0 offen sc1
    buffer_load_dwordx4 v[124:127], v122, s[24:27], 0 offen sc1
    buffer_load_dwordx4 v[152:155], v122, s[24:27], 0 offen offset:16 sc1
    buffer_load_dwordx4 v[156:159], v164, s[24:27], 0 offen sc1
    s_waitcnt vmcnt(0)
    s_branch g_poll_2
g_pollok_2:
    v_readfirstlane_b32 s59, v160
    s_waitcnt vmcnt(13) lgkmcnt(0)
    s_barrier
    v_mfma_f32_32x32x16_bf16 v[68:83], v[8:11], v[4:7], v[68:83]
    ds_read_b128 v[36:39], v118 offset:0
    ds_read_b64_tr_b16 v[40:41], v120 offset:18432
    ds_read_b64_tr_b16 v[42:43], v120 offset:19200
    v_mfma_f32_32x32x16_bf16 v[84:99], v[12:15], v[4:7], v[84:99]
    ds_read_b64_tr_b16 v[44:45], v120 offset:18496
    ds_read_b64_tr_b16 v[46:47], v120 offset:19264
    ds_read_b64_tr_b16 v[48:49], v120 offset:18560
    v_mfma_f32_32x32x16_bf16 v[100:115], v[16:19], v[4:7], v[100:115]
    ds_read_b64_tr_b16 v[50:51], v120 offset:19328
    ds_read_b128 v[52:55], v119 offset:0
    ds_read_b64_tr_b16 v[56:57], v120 offset:21504
    v_mfma_f32_32x32x16_bf16 v[68:83], v[24:27], v[20:23], v[68:83]
    ds_read_b64_tr_b16 v[58:59], v120 offset:22272
    ds_read_b64_tr_b16 v[60:61], v120 offset:21568
    ds_read_b64_tr_b16 v[62:63], v120 offset:22336
    v_mfma_f32_32x32x16_bf16 v[84:99], v[28:31], v[20:23], v[84:99]
    ds_read_b64_tr_b16 v[64:65], v120 offset:21632
    ds_read_b64_tr_b16 v[66:67], v120 offset:22400
    v_mfma_f32_32x32x16_bf16 v[100:115], v[32:35], v[20:23], v[100:115]
    s_cmp_ge_u32 s40, 3
    s_cbranch_scc1 g_noaext_2
    v_mov_b32 v168, v156
    v_mov_b32 v169, v158
    v_mov_b32 v2, v156
    v_mov_b32 v3, v158
    s_nop 1
    v_permlane32_swap_b32 v168, v2
    v_permlane32_swap_b32 v169, v3
    v_add_f32 v168, v168, v2
    v_add_f32 v169, v169, v3
    v_mov_b32 v2, v168
    v_mov_b32 v3, v169
    s_nop 1
    v_permlane16_swap_b32 v168, v2
    v_permlane16_swap_b32 v169, v3
    v_add_f32 v168, v168, v2
    v_add_f32 v169, v169, v3
    v_and_b32 v2, 15, v1
    v_lshlrev_b32 v2, 3, v2
    s_lshl_b32 s37, s40, 7
    s_add_u32 s37, s37, 81152
    v_add_u32 v2, s37, v2
    ds_write_b64 v2, v[168:169]
    v_lshlrev_b32 v3, 2, v162
    v_add_u32 v3, s37, v3
    ds_read_b32 v170, v3
g_noaext_2:
    s_waitcnt vmcnt(2) lgkmcnt(0)
    s_barrier
    v_mfma_f32_32x32x16_bf16 v[68:83], v[40:43], v[36:39], v[68:83]
    ds_read_b128 v[4:7], v116 offset:16384
    ds_read_b64_tr_b16 v[8:9], v120 offset:24576
    ds_read_b64_tr_b16 v[10:11], v120 offset:25344
    v_mfma_f32_32x32x16_bf16 v[84:99], v[44:47], v[36:39], v[84:99]
    ds_read_b64_tr_b16 v[12:13], v120 offset:24640
    ds_read_b64_tr_b16 v[14:15], v120 offset:25408
    ds_read_b64_tr_b16 v[16:17], v120 offset:24704
    v_mfma_f32_32x32x16_bf16 v[100:115], v[48:51], v[36:39], v[100:115]
    ds_read_b64_tr_b16 v[18:19], v120 offset:25472
    ds_read_b128 v[20:23], v117 offset:16384
    ds_read_b64_tr_b16 v[24:25], v120 offset:27648
    v_mfma_f32_32x32x16_bf16 v[68:83], v[56:59], v[52:55], v[68:83]
    ds_read_b64_tr_b16 v[26:27], v120 offset:28416
    ds_read_b64_tr_b16 v[28:29], v120 offset:27712
    ds_read_b64_tr_b16 v[30:31], v120 offset:28480
    v_mfma_f32_32x32x16_bf16 v[84:99], v[60:63], v[52:55], v[84:99]
    ds_read_b64_tr_b16 v[32:33], v120 offset:27776
    ds_read_b64_tr_b16 v[34:35], v120 offset:28544
    v_mfma_f32_32x32x16_bf16 v[100:115], v[64:67], v[52:55], v[100:115]
    s_cmp_ge_u32 s40, 3
    s_cbranch_scc1 g_noaext2_2
    s_mov_b32 s46, 0x05040100
    v_cvt_pk_bf16_f32 v2, v170, v170
    v_lshlrev_b32 v3, 16, v2
    v_sub_f32 v3, v170, v3
    v_cvt_pk_bf16_f32 v3, v3, v3
    v_cndmask_b32 v172, 0, v2, s[62:63]
    v_perm_b32 v175, v161, v3, s46
    v_cndmask_b32 v174, 0, v161, s[62:63]
    v_cndmask_b32 v173, 0, v175, s[62:63]
    v_mov_b32 v175, 0
    s_lshl_b32 s37, s40, 10
    v_add_u32 v2, s37, v123
    ds_write_b128 v2, v[172:175] offset:32768
g_noaext2_2:
    s_waitcnt vmcnt(0) lgkmcnt(0)
    s_barrier
    v_mfma_f32_32x32x16_bf16 v[68:83], v[8:11], v[4:7], v[68:83]
    ds_read_b128 v[36:39], v118 offset:16384
    ds_read_b64_tr_b16 v[40:41], v120 offset:0
    ds_read_b64_tr_b16 v[42:43], v120 offset:768
    v_mfma_f32_32x32x16_bf16 v[84:99], v[12:15], v[4:7], v[84:99]
    ds_read_b64_tr_b16 v[44:45], v120 offset:64
    ds_read_b64_tr_b16 v[46:47], v120 offset:832
    ds_read_b64_tr_b16 v[48:49], v120 offset:128
    v_mfma_f32_32x32x16_bf16 v[100:115], v[16:19], v[4:7], v[100:115]
    ds_read_b64_tr_b16 v[50:51], v120 offset:896
    ds_read_b128 v[52:55], v119 offset:16384
    ds_read_b64_tr_b16 v[56:57], v120 offset:3072
    v_mfma_f32_32x32x16_bf16 v[68:83], v[24:27], v[20:23], v[68:83]
    ds_read_b64_tr_b16 v[58:59], v120 offset:3840
    ds_read_b64_tr_b16 v[60:61], v120 offset:3136
    ds_read_b64_tr_b16 v[62:63], v120 offset:3904
    v_mfma_f32_32x32x16_bf16 v[84:99], v[28:31], v[20:23], v[84:99]
    ds_read_b64_tr_b16 v[64:65], v120 offset:3200
    ds_read_b64_tr_b16 v[66:67], v120 offset:3968
    v_mfma_f32_32x32x16_bf16 v[100:115], v[32:35], v[20:23], v[100:115]
    s_waitcnt lgkmcnt(0)
    v_mfma_f32_32x32x16_bf16 v[68:83], v[40:43], v[36:39], v[68:83]
    v_mfma_f32_32x32x16_bf16 v[84:99], v[44:47], v[36:39], v[84:99]
    v_mfma_f32_32x32x16_bf16 v[100:115], v[48:51], v[36:39], v[100:115]
    v_mfma_f32_32x32x16_bf16 v[68:83], v[56:59], v[52:55], v[68:83]
    v_mfma_f32_32x32x16_bf16 v[84:99], v[60:63], v[52:55], v[84:99]
    v_mfma_f32_32x32x16_bf16 v[100:115], v[64:67], v[52:55], v[100:115]
g_p1done:
    s_mov_b32 s44, s88
    s_mov_b32 s45, s89
    s_mov_b32 s46, 0x158000
    s_mov_b32 s47, 0x00020000
    s_lshr_b32 s50, s33, 3
    s_mul_i32 s50, s50, 344
    s_mul_i32 s49, s28, 86
    s_add_u32 s50, s50, s49
    s_lshl_b32 s50, s50, 7
    v_lshlrev_b32 v176, 7, v1
    buffer_load_dword v178, v176, s[44:47], s50 offen
    v_min_u32 v177, 21, v1
    v_lshlrev_b32 v177, 7, v177
    s_add_u32 s50, s50, 8192
    buffer_load_dword v179, v177, s[44:47], s50 offen
    s_barrier
    ds_read_b128 v[8:11], v123 offset:32768
    ds_read_b128 v[12:15], v123 offset:33792
    ds_read_b128 v[16:19], v123 offset:34816
    v_cndmask_b32 v4, 0, v124, s[62:63]
    v_cndmask_b32 v5, 0, v125, s[62:63]
    v_cndmask_b32 v6, 0, v126, s[62:63]
    v_mov_b32 v7, 0
    v_mov_b32 v116, v152
    v_mov_b32 v117, v152
    v_mov_b32 v122, 0xc0135761
    v_mov_b32 v123, 0xc0135761
    v_mov_b32 v124, 0xbdd2d3e8
    v_mov_b32 v125, 0xbdd2d3e8
    v_mov_b32 v126, 1.0
    v_mov_b32 v127, 1.0
    s_waitcnt lgkmcnt(0)
    v_mfma_f32_32x32x16_bf16 v[68:83], v[8:11], v[4:7], v[68:83]
    v_mfma_f32_32x32x16_bf16 v[84:99], v[12:15], v[4:7], v[84:99]
    v_mfma_f32_32x32x16_bf16 v[100:115], v[16:19], v[4:7], v[100:115]
    s_nop 7
    s_nop 3
    v_pk_mul_f32 v[68:69], v[68:69], v[116:117]
    v_pk_mul_f32 v[70:71], v[70:71], v[116:117]
    v_pk_mul_f32 v[72:73], v[72:73], v[116:117]
    v_pk_mul_f32 v[74:75], v[74:75], v[116:117]
    v_pk_mul_f32 v[24:25], v[68:69], v[68:69]
    v_pk_mul_f32 v[26:27], v[70:71], v[70:71]
    v_pk_mul_f32 v[28:29], v[72:73], v[72:73]
    v_pk_mul_f32 v[30:31], v[74:75], v[74:75]
    v_pk_fma_f32 v[24:25], v[24:25], v[124:125], v[122:123]
    v_pk_fma_f32 v[26:27], v[26:27], v[124:125], v[122:123]
    v_pk_fma_f32 v[28:29], v[28:29], v[124:125], v[122:123]
    v_pk_fma_f32 v[30:31], v[30:31], v[124:125], v[122:123]
    v_pk_mul_f32 v[24:25], v[24:25], v[68:69]
    v_pk_mul_f32 v[26:27], v[26:27], v[70:71]
    v_pk_mul_f32 v[28:29], v[28:29], v[72:73]
    v_pk_mul_f32 v[30:31], v[30:31], v[74:75]
    v_exp_f32 v32, v24
    v_exp_f32 v33, v25
    v_exp_f32 v34, v26
    v_exp_f32 v35, v27
    v_exp_f32 v36, v28
    v_exp_f32 v37, v29
    v_exp_f32 v38, v30
    v_exp_f32 v39, v31
    v_pk_add_f32 v[32:33], v[32:33], v[126:127]
    v_pk_add_f32 v[34:35], v[34:35], v[126:127]
    v_pk_add_f32 v[36:37], v[36:37], v[126:127]
    v_pk_add_f32 v[38:39], v[38:39], v[126:127]
    v_rcp_f32 v32, v32
    v_rcp_f32 v33, v33
    v_rcp_f32 v34, v34
    v_rcp_f32 v35, v35
    v_rcp_f32 v36, v36
    v_rcp_f32 v37, v37
    v_rcp_f32 v38, v38
    v_rcp_f32 v39, v39
    v_pk_mul_f32 v[68:69], v[68:69], v[32:33]
    v_pk_mul_f32 v[70:71], v[70:71], v[34:35]
    v_pk_mul_f32 v[72:73], v[72:73], v[36:37]
    v_pk_mul_f32 v[74:75], v[74:75], v[38:39]
    v_cvt_pk_bf16_f32 v208, v68, v69
    v_cvt_pk_bf16_f32 v209, v70, v71
    v_cvt_pk_bf16_f32 v210, v72, v73
    v_cvt_pk_bf16_f32 v211, v74, v75
    v_pk_mul_f32 v[76:77], v[76:77], v[116:117]
    v_pk_mul_f32 v[78:79], v[78:79], v[116:117]
    v_pk_mul_f32 v[80:81], v[80:81], v[116:117]
    v_pk_mul_f32 v[82:83], v[82:83], v[116:117]
    v_pk_mul_f32 v[24:25], v[76:77], v[76:77]
    v_pk_mul_f32 v[26:27], v[78:79], v[78:79]
    v_pk_mul_f32 v[28:29], v[80:81], v[80:81]
    v_pk_mul_f32 v[30:31], v[82:83], v[82:83]
    v_pk_fma_f32 v[24:25], v[24:25], v[124:125], v[122:123]
    v_pk_fma_f32 v[26:27], v[26:27], v[124:125], v[122:123]
    v_pk_fma_f32 v[28:29], v[28:29], v[124:125], v[122:123]
    v_pk_fma_f32 v[30:31], v[30:31], v[124:125], v[122:123]
    v_pk_mul_f32 v[24:25], v[24:25], v[76:77]
    v_pk_mul_f32 v[26:27], v[26:27], v[78:79]
    v_pk_mul_f32 v[28:29], v[28:29], v[80:81]
    v_pk_mul_f32 v[30:31], v[30:31], v[82:83]
    v_exp_f32 v32, v24
    v_exp_f32 v33, v25
    v_exp_f32 v34, v26
    v_exp_f32 v35, v27
    v_exp_f32 v36, v28
    v_exp_f32 v37, v29
    v_exp_f32 v38, v30
    v_exp_f32 v39, v31
    v_pk_add_f32 v[32:33], v[32:33], v[126:127]
    v_pk_add_f32 v[34:35], v[34:35], v[126:127]
    v_pk_add_f32 v[36:37], v[36:37], v[126:127]
    v_pk_add_f32 v[38:39], v[38:39], v[126:127]
    v_rcp_f32 v32, v32
    v_rcp_f32 v33, v33
    v_rcp_f32 v34, v34
    v_rcp_f32 v35, v35
    v_rcp_f32 v36, v36
    v_rcp_f32 v37, v37
    v_rcp_f32 v38, v38
    v_rcp_f32 v39, v39
    v_pk_mul_f32 v[76:77], v[76:77], v[32:33]
    v_pk_mul_f32 v[78:79], v[78:79], v[34:35]
    v_pk_mul_f32 v[80:81], v[80:81], v[36:37]
    v_pk_mul_f32 v[82:83], v[82:83], v[38:39]
    v_cvt_pk_bf16_f32 v212, v76, v77
    v_cvt_pk_bf16_f32 v213, v78, v79
    v_cvt_pk_bf16_f32 v214, v80, v81
    v_cvt_pk_bf16_f32 v215, v82, v83
    v_pk_mul_f32 v[84:85], v[84:85], v[116:117]
    v_pk_mul_f32 v[86:87], v[86:87], v[116:117]
    v_pk_mul_f32 v[88:89], v[88:89], v[116:117]
    v_pk_mul_f32 v[90:91], v[90:91], v[116:117]
    v_pk_mul_f32 v[24:25], v[84:85], v[84:85]
    v_pk_mul_f32 v[26:27], v[86:87], v[86:87]
    v_pk_mul_f32 v[28:29], v[88:89], v[88:89]
    v_pk_mul_f32 v[30:31], v[90:91], v[90:91]
    v_pk_fma_f32 v[24:25], v[24:25], v[124:125], v[122:123]
    v_pk_fma_f32 v[26:27], v[26:27], v[124:125], v[122:123]
    v_pk_fma_f32 v[28:29], v[28:29], v[124:125], v[122:123]
    v_pk_fma_f32 v[30:31], v[30:31], v[124:125], v[122:123]
    v_pk_mul_f32 v[24:25], v[24:25], v[84:85]
    v_pk_mul_f32 v[26:27], v[26:27], v[86:87]
    v_pk_mul_f32 v[28:29], v[28:29], v[88:89]
    v_pk_mul_f32 v[30:31], v[30:31], v[90:91]
    v_exp_f32 v32, v24
    v_exp_f32 v33, v25
    v_exp_f32 v34, v26
    v_exp_f32 v35, v27
    v_exp_f32 v36, v28
    v_exp_f32 v37, v29
    v_exp_f32 v38, v30
    v_exp_f32 v39, v31
    v_pk_add_f32 v[32:33], v[32:33], v[126:127]
    v_pk_add_f32 v[34:35], v[34:35], v[126:127]
    v_pk_add_f32 v[36:37], v[36:37], v[126:127]
    v_pk_add_f32 v[38:39], v[38:39], v[126:127]
    v_rcp_f32 v32, v32
    v_rcp_f32 v33, v33
    v_rcp_f32 v34, v34
    v_rcp_f32 v35, v35
    v_rcp_f32 v36, v36
    v_rcp_f32 v37, v37
    v_rcp_f32 v38, v38
    v_rcp_f32 v39, v39
    v_pk_mul_f32 v[84:85], v[84:85], v[32:33]
    v_pk_mul_f32 v[86:87], v[86:87], v[34:35]
    v_pk_mul_f32 v[88:89], v[88:89], v[36:37]
    v_pk_mul_f32 v[90:91], v[90:91], v[38:39]
    v_cvt_pk_bf16_f32 v216, v84, v85
    v_cvt_pk_bf16_f32 v217, v86, v87
    v_cvt_pk_bf16_f32 v218, v88, v89
    v_cvt_pk_bf16_f32 v219, v90, v91
    v_pk_mul_f32 v[92:93], v[92:93], v[116:117]
    v_pk_mul_f32 v[94:95], v[94:95], v[116:117]
    v_pk_mul_f32 v[96:97], v[96:97], v[116:117]
    v_pk_mul_f32 v[98:99], v[98:99], v[116:117]
    v_pk_mul_f32 v[24:25], v[92:93], v[92:93]
    v_pk_mul_f32 v[26:27], v[94:95], v[94:95]
    v_pk_mul_f32 v[28:29], v[96:97], v[96:97]
    v_pk_mul_f32 v[30:31], v[98:99], v[98:99]
    v_pk_fma_f32 v[24:25], v[24:25], v[124:125], v[122:123]
    v_pk_fma_f32 v[26:27], v[26:27], v[124:125], v[122:123]
    v_pk_fma_f32 v[28:29], v[28:29], v[124:125], v[122:123]
    v_pk_fma_f32 v[30:31], v[30:31], v[124:125], v[122:123]
    v_pk_mul_f32 v[24:25], v[24:25], v[92:93]
    v_pk_mul_f32 v[26:27], v[26:27], v[94:95]
    v_pk_mul_f32 v[28:29], v[28:29], v[96:97]
    v_pk_mul_f32 v[30:31], v[30:31], v[98:99]
    v_exp_f32 v32, v24
    v_exp_f32 v33, v25
    v_exp_f32 v34, v26
    v_exp_f32 v35, v27
    v_exp_f32 v36, v28
    v_exp_f32 v37, v29
    v_exp_f32 v38, v30
    v_exp_f32 v39, v31
    v_pk_add_f32 v[32:33], v[32:33], v[126:127]
    v_pk_add_f32 v[34:35], v[34:35], v[126:127]
    v_pk_add_f32 v[36:37], v[36:37], v[126:127]
    v_pk_add_f32 v[38:39], v[38:39], v[126:127]
    v_rcp_f32 v32, v32
    v_rcp_f32 v33, v33
    v_rcp_f32 v34, v34
    v_rcp_f32 v35, v35
    v_rcp_f32 v36, v36
    v_rcp_f32 v37, v37
    v_rcp_f32 v38, v38
    v_rcp_f32 v39, v39
    v_pk_mul_f32 v[92:93], v[92:93], v[32:33]
    v_pk_mul_f32 v[94:95], v[94:95], v[34:35]
    v_pk_mul_f32 v[96:97], v[96:97], v[36:37]
    v_pk_mul_f32 v[98:99], v[98:99], v[38:39]
    v_cvt_pk_bf16_f32 v220, v92, v93
    v_cvt_pk_bf16_f32 v221, v94, v95
    v_cvt_pk_bf16_f32 v222, v96, v97
    v_cvt_pk_bf16_f32 v223, v98, v99
    s_cmp_ge_u32 s30, 11
    s_cbranch_scc1 g1_d2
    v_pk_mul_f32 v[100:101], v[100:101], v[116:117]
    v_pk_mul_f32 v[102:103], v[102:103], v[116:117]
    v_pk_mul_f32 v[104:105], v[104:105], v[116:117]
    v_pk_mul_f32 v[106:107], v[106:107], v[116:117]
    v_pk_mul_f32 v[24:25], v[100:101], v[100:101]
    v_pk_mul_f32 v[26:27], v[102:103], v[102:103]
    v_pk_mul_f32 v[28:29], v[104:105], v[104:105]
    v_pk_mul_f32 v[30:31], v[106:107], v[106:107]
    v_pk_fma_f32 v[24:25], v[24:25], v[124:125], v[122:123]
    v_pk_fma_f32 v[26:27], v[26:27], v[124:125], v[122:123]
    v_pk_fma_f32 v[28:29], v[28:29], v[124:125], v[122:123]
    v_pk_fma_f32 v[30:31], v[30:31], v[124:125], v[122:123]
    v_pk_mul_f32 v[24:25], v[24:25], v[100:101]
    v_pk_mul_f32 v[26:27], v[26:27], v[102:103]
    v_pk_mul_f32 v[28:29], v[28:29], v[104:105]
    v_pk_mul_f32 v[30:31], v[30:31], v[106:107]
    v_exp_f32 v32, v24
    v_exp_f32 v33, v25
    v_exp_f32 v34, v26
    v_exp_f32 v35, v27
    v_exp_f32 v36, v28
    v_exp_f32 v37, v29
    v_exp_f32 v38, v30
    v_exp_f32 v39, v31
    v_pk_add_f32 v[32:33], v[32:33], v[126:127]
    v_pk_add_f32 v[34:35], v[34:35], v[126:127]
    v_pk_add_f32 v[36:37], v[36:37], v[126:127]
    v_pk_add_f32 v[38:39], v[38:39], v[126:127]
    v_rcp_f32 v32, v32
    v_rcp_f32 v33, v33
    v_rcp_f32 v34, v34
    v_rcp_f32 v35, v35
    v_rcp_f32 v36, v36
    v_rcp_f32 v37, v37
    v_rcp_f32 v38, v38
    v_rcp_f32 v39, v39
    v_pk_mul_f32 v[100:101], v[100:101], v[32:33]
    v_pk_mul_f32 v[102:103], v[102:103], v[34:35]
    v_pk_mul_f32 v[104:105], v[104:105], v[36:37]
    v_pk_mul_f32 v[106:107], v[106:107], v[38:39]
    v_cvt_pk_bf16_f32 v224, v100, v101
    v_cvt_pk_bf16_f32 v225, v102, v103
    v_cvt_pk_bf16_f32 v226, v104, v105
    v_cvt_pk_bf16_f32 v227, v106, v107
    v_pk_mul_f32 v[108:109], v[108:109], v[116:117]
    v_pk_mul_f32 v[110:111], v[110:111], v[116:117]
    v_pk_mul_f32 v[112:113], v[112:113], v[116:117]
    v_pk_mul_f32 v[114:115], v[114:115], v[116:117]
    v_pk_mul_f32 v[24:25], v[108:109], v[108:109]
    v_pk_mul_f32 v[26:27], v[110:111], v[110:111]
    v_pk_mul_f32 v[28:29], v[112:113], v[112:113]
    v_pk_mul_f32 v[30:31], v[114:115], v[114:115]
    v_pk_fma_f32 v[24:25], v[24:25], v[124:125], v[122:123]
    v_pk_fma_f32 v[26:27], v[26:27], v[124:125], v[122:123]
    v_pk_fma_f32 v[28:29], v[28:29], v[124:125], v[122:123]
    v_pk_fma_f32 v[30:31], v[30:31], v[124:125], v[122:123]
    v_pk_mul_f32 v[24:25], v[24:25], v[108:109]
    v_pk_mul_f32 v[26:27], v[26:27], v[110:111]
    v_pk_mul_f32 v[28:29], v[28:29], v[112:113]
    v_pk_mul_f32 v[30:31], v[30:31], v[114:115]
    v_exp_f32 v32, v24
    v_exp_f32 v33, v25
    v_exp_f32 v34, v26
    v_exp_f32 v35, v27
    v_exp_f32 v36, v28
    v_exp_f32 v37, v29
    v_exp_f32 v38, v30
    v_exp_f32 v39, v31
    v_pk_add_f32 v[32:33], v[32:33], v[126:127]
    v_pk_add_f32 v[34:35], v[34:35], v[126:127]
    v_pk_add_f32 v[36:37], v[36:37], v[126:127]
    v_pk_add_f32 v[38:39], v[38:39], v[126:127]
    v_rcp_f32 v32, v32
    v_rcp_f32 v33, v33
    v_rcp_f32 v34, v34
    v_rcp_f32 v35, v35
    v_rcp_f32 v36, v36
    v_rcp_f32 v37, v37
    v_rcp_f32 v38, v38
    v_rcp_f32 v39, v39
    v_pk_mul_f32 v[108:109], v[108:109], v[32:33]
    v_pk_mul_f32 v[110:111], v[110:111], v[34:35]
    v_pk_mul_f32 v[112:113], v[112:113], v[36:37]
    v_pk_mul_f32 v[114:115], v[114:115], v[38:39]
    v_cvt_pk_bf16_f32 v228, v108, v109
    v_cvt_pk_bf16_f32 v229, v110, v111
    v_cvt_pk_bf16_f32 v230, v112, v113
    v_cvt_pk_bf16_f32 v231, v114, v115
    buffer_store_dwordx4 v[208:211], v121, s[24:27], s60 offen sc1
    buffer_store_dwordx4 v[212:215], v121, s[24:27], s60 offen offset:256 sc1
    s_add_u32 s60, s60, 4096
    buffer_store_dwordx4 v[216:219], v121, s[24:27], s60 offen sc1
    buffer_store_dwordx4 v[220:223], v121, s[24:27], s60 offen offset:256 sc1
    s_add_u32 s60, s60, 4096
    buffer_store_dwordx4 v[224:227], v121, s[24:27], s60 offen sc1
    buffer_store_dwordx4 v[228:231], v121, s[24:27], s60 offen offset:256 sc1
    s_add_u32 s60, s60, 4096
    s_branch g1_done
g1_d2:
    buffer_store_dwordx4 v[208:211], v121, s[24:27], s60 offen sc1
    buffer_store_dwordx4 v[212:215], v121, s[24:27], s60 offen offset:256 sc1
    s_add_u32 s60, s60, 4096
    buffer_store_dwordx4 v[216:219], v121, s[24:27], s60 offen sc1
    buffer_store_dwordx4 v[220:223], v121, s[24:27], s60 offen offset:256 sc1
    s_add_u32 s60, s60, 4096
g1_done:
    s_setprio 0
    s_lshr_b32 s37, s30, 3
    s_lshl_b32 s56, s29, 1
    s_add_u32 s56, s56, s37
    s_and_b32 s57, s30, 7
    v_lshlrev_b32 v2, 4, v1
    s_add_u32 s37, s28, 0
    s_and_b32 s37, s37, 3
    s_lshl_b32 s37, s37, 10
    v_add_u32 v4, s37, v2
    s_add_u32 s37, s28, 1
    s_and_b32 s37, s37, 3
    s_lshl_b32 s37, s37, 10
    v_add_u32 v5, s37, v2
    s_add_u32 s37, s28, 2
    s_and_b32 s37, s37, 3
    s_lshl_b32 s37, s37, 10
    v_add_u32 v6, s37, v2
    s_add_u32 s37, s28, 3
    s_and_b32 s37, s37, 3
    s_lshl_b32 s37, s37, 10
    v_add_u32 v7, s37, v2
    v_lshrrev_b32 v10, 3, v1
    v_and_b32 v11, 7, v1
    v_bfe_u32 v12, v10, 1, 1
    v_lshlrev_b32 v12, 1, v12
    v_xor_b32 v11, v11, v12
    v_lshlrev_b32 v11, 4, v11
    v_lshl_add_u32 v8, v10, 10, v11
    v_xor_b32 v9, 64, v8
    s_mul_i32 s38, s56, 176128
    s_lshl_b32 s37, s28, 12
    s_add_u32 s38, s38, s37
    s_lshl_b32 s39, s28, 15
    s_lshl_b32 s37, s57, 7
    s_add_u32 s39, s39, s37
    s_mul_i32 s42, s28, 16384
    s_mov_b32 s44, s88
    s_mov_b32 s45, s89
    s_mov_b32 s46, 0x158000
    s_mov_b32 s47, 0x00020000
    s_mov_b32 s16, s84
    s_mov_b32 s17, s85
    s_mov_b32 s18, 0x400
    s_mov_b32 s19, 0x00020000
    s_mov_b32 s20, s86
    s_mov_b32 s21, s87
    s_mov_b32 s22, 0x200000
    s_mov_b32 s23, 0x00020000
    v_lshrrev_b32 v12, 4, v1
    v_bfe_u32 v13, v1, 2, 2
    v_lshl_add_u32 v14, v12, 3, v13
    v_lshlrev_b32 v14, 7, v14
    v_and_b32 v15, 3, v1
    v_lshl_add_u32 v14, v15, 3, v14
    v_bfe_u32 v13, v13, 1, 1
    v_and_b32 v15, 1, v12
    v_lshl_add_u32 v13, v15, 1, v13
    v_lshl_add_u32 v14, v13, 5, v14
    v_add_u32 v162, s42, v14
    v_xor_b32 v163, 32, v162
    v_xor_b32 v164, 64, v162
    v_xor_b32 v165, 96, v162
    s_waitcnt vmcnt(0)
    s_barrier
    s_cmp_lg_u32 s28, 0
    s_cbranch_scc1 fl_2
    s_lshl_b32 s58, s29, 4
    s_add_u32 s58, s58, s30
    s_lshl_b32 s58, s58, 7
    s_add_u32 s58, s58, 14942208
    v_mov_b32 v2, s59
    v_mov_b32 v3, 0
    s_mov_b64 s[92:93], exec
    s_mov_b64 exec, 1
    buffer_store_dword v2, v3, s[24:27], s58 offen sc1
    s_mov_b64 exec, s[92:93]
fl_2:
    s_add_u32 m0, s42, 0
    s_add_u32 s40, s39, 0
    buffer_load_dwordx4 v8, s[44:47], s40 offen lds
    s_add_u32 m0, s42, 1024
    s_add_u32 s40, s39, 8192
    buffer_load_dwordx4 v9, s[44:47], s40 offen lds
    s_add_u32 m0, s42, 2048
    s_add_u32 s40, s39, 16384
    buffer_load_dwordx4 v8, s[44:47], s40 offen lds
    s_add_u32 m0, s42, 3072
    s_add_u32 s40, s39, 24576
    buffer_load_dwordx4 v9, s[44:47], s40 offen lds
    s_add_u32 s39, s39, 131072
    s_add_u32 m0, s42, 4096
    s_add_u32 s40, s39, 0
    buffer_load_dwordx4 v8, s[44:47], s40 offen lds
    s_add_u32 m0, s42, 5120
    s_add_u32 s40, s39, 8192
    buffer_load_dwordx4 v9, s[44:47], s40 offen lds
    s_add_u32 m0, s42, 6144
    s_add_u32 s40, s39, 16384
    buffer_load_dwordx4 v8, s[44:47], s40 offen lds
    s_add_u32 m0, s42, 7168
    s_add_u32 s40, s39, 24576
    buffer_load_dwordx4 v9, s[44:47], s40 offen lds
    s_add_u32 s39, s39, 131072
    s_add_u32 m0, s42, 8192
    s_add_u32 s40, s39, 0
    buffer_load_dwordx4 v8, s[44:47], s40 offen lds
    s_add_u32 m0, s42, 9216
    s_add_u32 s40, s39, 8192
    buffer_load_dwordx4 v9, s[44:47], s40 offen lds
    s_add_u32 m0, s42, 10240
    s_add_u32 s40, s39, 16384
    buffer_load_dwordx4 v8, s[44:47], s40 offen lds
    s_add_u32 m0, s42, 11264
    s_add_u32 s40, s39, 24576
    buffer_load_dwordx4 v9, s[44:47], s40 offen lds
    s_add_u32 s39, s39, 131072
    v_lshrrev_b32 v13, 3, v1
    v_and_b32 v15, 7, v1
    s_lshl_b32 s40, s56, 6
    s_lshl_b32 s41, s28, 4
    s_add_u32 s40, s40, s41
    v_add_u32 v13, s40, v13
    v_lshlrev_b32 v13, 10, v13
    v_lshl_add_u32 v166, v15, 4, v13
    s_lshl_b32 s41, s57, 7
    v_add_u32 v166, s41, v166
    v_lshlrev_b32 v13, 4, v15
    v_add_u32 v13, s41, v13
    s_movk_i32 s40, 0x2000
    buffer_load_dwordx4 v[168:171], v166, s[12:15], 0 offen
    buffer_load_dwordx4 v[172:175], v166, s[12:15], s40 offen
    buffer_load_dwordx4 v[176:179], v13, s[16:19], 0 offen
    v_lshrrev_b32 v180, 3, v0
    v_bfe_u32 v181, v0, 1, 2
    v_and_b32 v182, 1, v0
    s_lshl_b32 s40, s57, 6
    v_add_u32 v183, s40, v180
    v_lshlrev_b32 v183, 12, v183
    v_lshl_add_u32 v183, v181, 10, v183
    v_lshl_add_u32 v183, v182, 4, v183
    s_lshl_b32 s50, s56, 5
    s_add_u32 s50, s50, 12582912
    s_add_u32 s51, s50, 131072
    v_lshlrev_b32 v180, 7, v180
    v_lshl_add_u32 v180, v182, 6, v180
    v_lshl_add_u32 v180, v181, 4, v180
    v_add_u32 v180, 66560, v180
    v_lshlrev_b32 v193, 7, v1
    s_lshl_b32 s52, s57, 12
    s_add_u32 s52, s52, 15007744
    s_lshl_b32 s53, s29, 11
    s_add_u32 s53, s53, 14942208
    v_mov_b32 v16, 0
    v_mov_b32 v17, 0
    v_mov_b32 v18, 0
    v_mov_b32 v19, 0
    v_mov_b32 v20, 0
    v_mov_b32 v21, 0
    v_mov_b32 v22, 0
    v_mov_b32 v23, 0
    v_mov_b32 v24, 0
    v_mov_b32 v25, 0
    v_mov_b32 v26, 0
    v_mov_b32 v27, 0
    v_mov_b32 v28, 0
    v_mov_b32 v29, 0
    v_mov_b32 v30, 0
    v_mov_b32 v31, 0
    v_mov_b32 v32, 0
    v_mov_b32 v33, 0
    v_mov_b32 v34, 0
    v_mov_b32 v35, 0
    v_mov_b32 v36, 0
    v_mov_b32 v37, 0
    v_mov_b32 v38, 0
    v_mov_b32 v39, 0
    v_mov_b32 v40, 0
    v_mov_b32 v41, 0
    v_mov_b32 v42, 0
    v_mov_b32 v43, 0
    v_mov_b32 v44, 0
    v_mov_b32 v45, 0
    v_mov_b32 v46, 0
    v_mov_b32 v47, 0
    v_mov_b32 v48, 0
    v_mov_b32 v49, 0
    v_mov_b32 v50, 0
    v_mov_b32 v51, 0
    v_mov_b32 v52, 0
    v_mov_b32 v53, 0
    v_mov_b32 v54, 0
    v_mov_b32 v55, 0
    v_mov_b32 v56, 0
    v_mov_b32 v57, 0
    v_mov_b32 v58, 0
    v_mov_b32 v59, 0
    v_mov_b32 v60, 0
    v_mov_b32 v61, 0
    v_mov_b32 v62, 0
    v_mov_b32 v63, 0
    v_mov_b32 v64, 0
    v_mov_b32 v65, 0
    v_mov_b32 v66, 0
    v_mov_b32 v67, 0
    v_mov_b32 v68, 0
    v_mov_b32 v69, 0
    v_mov_b32 v70, 0
    v_mov_b32 v71, 0
    v_mov_b32 v72, 0
    v_mov_b32 v73, 0
    v_mov_b32 v74, 0
    v_mov_b32 v75, 0
    v_mov_b32 v76, 0
    v_mov_b32 v77, 0
    v_mov_b32 v78, 0
    v_mov_b32 v79, 0
    s_mov_b32 s98, 0
g_hf:
    s_mov_b32 exec_lo, 0xffff
    s_mov_b32 exec_hi, 0x0
    buffer_load_dword v194, v193, s[24:27], s53 offen sc1
    s_mov_b64 exec, -1
    s_waitcnt vmcnt(0)
    v_cmp_ne_u32 vcc, s59, v194
    s_mov_b32 s96, 0xffff
    s_mov_b32 s97, 0x0
    s_and_b64 vcc, vcc, s[96:97]
    s_cmp_eq_u64 vcc, 0
    s_cbranch_scc1 g_hfok
    s_add_u32 s98, s98, 1
    s_cmp_gt_u32 s98, 20000
    s_cbranch_scc1 g_hfok
    s_sleep 8
    s_branch g_hf
g_hfok:
    buffer_load_dwordx4 v[80:83], v4, s[24:27], s38 offen sc1
    buffer_load_dwordx4 v[84:87], v5, s[24:27], s38 offen sc1
    buffer_load_dwordx4 v[88:91], v6, s[24:27], s38 offen sc1
    buffer_load_dwordx4 v[92:95], v7, s[24:27], s38 offen sc1
    s_add_u32 s38, s38, 16384
    buffer_load_dwordx4 v[96:99], v4, s[24:27], s38 offen sc1
    buffer_load_dwordx4 v[100:103], v5, s[24:27], s38 offen sc1
    buffer_load_dwordx4 v[104:107], v6, s[24:27], s38 offen sc1
    buffer_load_dwordx4 v[108:111], v7, s[24:27], s38 offen sc1
    s_add_u32 s38, s38, 16384
    buffer_load_dwordx4 v[112:115], v4, s[24:27], s38 offen sc1
    buffer_load_dwordx4 v[116:119], v5, s[24:27], s38 offen sc1
    buffer_load_dwordx4 v[120:123], v6, s[24:27], s38 offen sc1
    buffer_load_dwordx4 v[124:127], v7, s[24:27], s38 offen sc1
    s_add_u32 s38, s38, 16384
    v_lshlrev_b32 v232, 16, v168
    v_and_b32 v233, 0xffff0000, v168
    v_lshlrev_b32 v234, 16, v169
    v_and_b32 v235, 0xffff0000, v169
    v_lshlrev_b32 v236, 16, v170
    v_and_b32 v237, 0xffff0000, v170
    v_lshlrev_b32 v238, 16, v171
    v_and_b32 v239, 0xffff0000, v171
    v_lshlrev_b32 v240, 16, v172
    v_and_b32 v241, 0xffff0000, v172
    v_lshlrev_b32 v242, 16, v173
    v_and_b32 v243, 0xffff0000, v173
    v_lshlrev_b32 v244, 16, v174
    v_and_b32 v245, 0xffff0000, v174
    v_lshlrev_b32 v246, 16, v175
    v_and_b32 v247, 0xffff0000, v175
    v_lshlrev_b32 v184, 16, v176
    v_and_b32 v185, 0xffff0000, v176
    v_lshlrev_b32 v186, 16, v177
    v_and_b32 v187, 0xffff0000, v177
    v_lshlrev_b32 v188, 16, v178
    v_and_b32 v189, 0xffff0000, v178
    v_lshlrev_b32 v190, 16, v179
    v_and_b32 v191, 0xffff0000, v179
    v_pk_add_f32 v[232:233], v[232:233], v[184:185]
    v_pk_add_f32 v[234:235], v[234:235], v[186:187]
    v_pk_add_f32 v[236:237], v[236:237], v[188:189]
    v_pk_add_f32 v[238:239], v[238:239], v[190:191]
    v_pk_add_f32 v[240:241], v[240:241], v[184:185]
    v_pk_add_f32 v[242:243], v[242:243], v[186:187]
    v_pk_add_f32 v[244:245], v[244:245], v[188:189]
    v_pk_add_f32 v[246:247], v[246:247], v[190:191]
    ds_read_b64_tr_b16 v[200:201], v162 offset:0
    ds_read_b64_tr_b16 v[202:203], v162 offset:512
    ds_read_b64_tr_b16 v[204:205], v163 offset:0
    ds_read_b64_tr_b16 v[206:207], v163 offset:512
    ds_read_b64_tr_b16 v[208:209], v164 offset:0
    ds_read_b64_tr_b16 v[210:211], v164 offset:512
    ds_read_b64_tr_b16 v[212:213], v165 offset:0
    ds_read_b64_tr_b16 v[214:215], v165 offset:512
    s_waitcnt vmcnt(8) lgkmcnt(0)
    v_mfma_f32_16x16x32_bf16 v[16:19], v[200:203], v[80:83], v[16:19]
    ds_read_b64_tr_b16 v[216:217], v162 offset:4096
    v_mfma_f32_16x16x32_bf16 v[20:23], v[204:207], v[80:83], v[20:23]
    ds_read_b64_tr_b16 v[218:219], v162 offset:4608
    v_mfma_f32_16x16x32_bf16 v[24:27], v[208:211], v[80:83], v[24:27]
    ds_read_b64_tr_b16 v[220:221], v163 offset:4096
    v_mfma_f32_16x16x32_bf16 v[28:31], v[212:215], v[80:83], v[28:31]
    ds_read_b64_tr_b16 v[222:223], v163 offset:4608
    v_mfma_f32_16x16x32_bf16 v[32:35], v[200:203], v[84:87], v[32:35]
    ds_read_b64_tr_b16 v[224:225], v164 offset:4096
    v_mfma_f32_16x16x32_bf16 v[36:39], v[204:207], v[84:87], v[36:39]
    ds_read_b64_tr_b16 v[226:227], v164 offset:4608
    v_mfma_f32_16x16x32_bf16 v[40:43], v[208:211], v[84:87], v[40:43]
    ds_read_b64_tr_b16 v[228:229], v165 offset:4096
    v_mfma_f32_16x16x32_bf16 v[44:47], v[212:215], v[84:87], v[44:47]
    ds_read_b64_tr_b16 v[230:231], v165 offset:4608
    v_mfma_f32_16x16x32_bf16 v[48:51], v[200:203], v[88:91], v[48:51]
    v_mfma_f32_16x16x32_bf16 v[52:55], v[204:207], v[88:91], v[52:55]
    v_mfma_f32_16x16x32_bf16 v[56:59], v[208:211], v[88:91], v[56:59]
    v_mfma_f32_16x16x32_bf16 v[60:63], v[212:215], v[88:91], v[60:63]
    v_mfma_f32_16x16x32_bf16 v[64:67], v[200:203], v[92:95], v[64:67]
    v_mfma_f32_16x16x32_bf16 v[68:71], v[204:207], v[92:95], v[68:71]
    v_mfma_f32_16x16x32_bf16 v[72:75], v[208:211], v[92:95], v[72:75]
    v_mfma_f32_16x16x32_bf16 v[76:79], v[212:215], v[92:95], v[76:79]
    s_add_u32 m0, s42, 12288
    s_add_u32 s40, s39, 0
    buffer_load_dwordx4 v8, s[44:47], s40 offen lds
    s_add_u32 m0, s42, 13312
    s_add_u32 s40, s39, 8192
    buffer_load_dwordx4 v9, s[44:47], s40 offen lds
    s_add_u32 m0, s42, 14336
    s_add_u32 s40, s39, 16384
    buffer_load_dwordx4 v8, s[44:47], s40 offen lds
    s_add_u32 m0, s42, 15360
    s_add_u32 s40, s39, 24576
    buffer_load_dwordx4 v9, s[44:47], s40 offen lds
    s_add_u32 s39, s39, 131072
    buffer_load_dwordx4 v[128:131], v4, s[24:27], s38 offen sc1
    buffer_load_dwordx4 v[132:135], v5, s[24:27], s38 offen sc1
    buffer_load_dwordx4 v[136:139], v6, s[24:27], s38 offen sc1
    buffer_load_dwordx4 v[140:143], v7, s[24:27], s38 offen sc1
    s_add_u32 s38, s38, 16384
    s_waitcnt vmcnt(12) lgkmcnt(0)
    v_mfma_f32_16x16x32_bf16 v[16:19], v[216:219], v[96:99], v[16:19]
    ds_read_b64_tr_b16 v[200:201], v162 offset:8192
    v_mfma_f32_16x16x32_bf16 v[20:23], v[220:223], v[96:99], v[20:23]
    ds_read_b64_tr_b16 v[202:203], v162 offset:8704
    v_mfma_f32_16x16x32_bf16 v[24:27], v[224:227], v[96:99], v[24:27]
    ds_read_b64_tr_b16 v[204:205], v163 offset:8192
    v_mfma_f32_16x16x32_bf16 v[28:31], v[228:231], v[96:99], v[28:31]
    ds_read_b64_tr_b16 v[206:207], v163 offset:8704
    v_mfma_f32_16x16x32_bf16 v[32:35], v[216:219], v[100:103], v[32:35]
    ds_read_b64_tr_b16 v[208:209], v164 offset:8192
    v_mfma_f32_16x16x32_bf16 v[36:39], v[220:223], v[100:103], v[36:39]
    ds_read_b64_tr_b16 v[210:211], v164 offset:8704
    v_mfma_f32_16x16x32_bf16 v[40:43], v[224:227], v[100:103], v[40:43]
    ds_read_b64_tr_b16 v[212:213], v165 offset:8192
    v_mfma_f32_16x16x32_bf16 v[44:47], v[228:231], v[100:103], v[44:47]
    ds_read_b64_tr_b16 v[214:215], v165 offset:8704
    v_mfma_f32_16x16x32_bf16 v[48:51], v[216:219], v[104:107], v[48:51]
    v_mfma_f32_16x16x32_bf16 v[52:55], v[220:223], v[104:107], v[52:55]
    v_mfma_f32_16x16x32_bf16 v[56:59], v[224:227], v[104:107], v[56:59]
    v_mfma_f32_16x16x32_bf16 v[60:63], v[228:231], v[104:107], v[60:63]
    v_mfma_f32_16x16x32_bf16 v[64:67], v[216:219], v[108:111], v[64:67]
    v_mfma_f32_16x16x32_bf16 v[68:71], v[220:223], v[108:111], v[68:71]
    v_mfma_f32_16x16x32_bf16 v[72:75], v[224:227], v[108:111], v[72:75]
    v_mfma_f32_16x16x32_bf16 v[76:79], v[228:231], v[108:111], v[76:79]
    s_add_u32 m0, s42, 0
    s_add_u32 s40, s39, 0
    buffer_load_dwordx4 v8, s[44:47], s40 offen lds
    s_add_u32 m0, s42, 1024
    s_add_u32 s40, s39, 8192
    buffer_load_dwordx4 v9, s[44:47], s40 offen lds
    s_add_u32 m0, s42, 2048
    s_add_u32 s40, s39, 16384
    buffer_load_dwordx4 v8, s[44:47], s40 offen lds
    s_add_u32 m0, s42, 3072
    s_add_u32 s40, s39, 24576
    buffer_load_dwordx4 v9, s[44:47], s40 offen lds
    s_add_u32 s39, s39, 131072
    buffer_load_dwordx4 v[80:83], v4, s[24:27], s38 offen sc1
    buffer_load_dwordx4 v[84:87], v5, s[24:27], s38 offen sc1
    buffer_load_dwordx4 v[88:91], v6, s[24:27], s38 offen sc1
    buffer_load_dwordx4 v[92:95], v7, s[24:27], s38 offen sc1
    s_add_u32 s38, s38, 16384
    s_waitcnt vmcnt(12) lgkmcnt(0)
    v_mfma_f32_16x16x32_bf16 v[16:19], v[200:203], v[112:115], v[16:19]
    ds_read_b64_tr_b16 v[216:217], v162 offset:12288
    v_mfma_f32_16x16x32_bf16 v[20:23], v[204:207], v[112:115], v[20:23]
    ds_read_b64_tr_b16 v[218:219], v162 offset:12800
    v_mfma_f32_16x16x32_bf16 v[24:27], v[208:211], v[112:115], v[24:27]
    ds_read_b64_tr_b16 v[220:221], v163 offset:12288
    v_mfma_f32_16x16x32_bf16 v[28:31], v[212:215], v[112:115], v[28:31]
    ds_read_b64_tr_b16 v[222:223], v163 offset:12800
    v_mfma_f32_16x16x32_bf16 v[32:35], v[200:203], v[116:119], v[32:35]
    ds_read_b64_tr_b16 v[224:225], v164 offset:12288
    v_mfma_f32_16x16x32_bf16 v[36:39], v[204:207], v[116:119], v[36:39]
    ds_read_b64_tr_b16 v[226:227], v164 offset:12800
    v_mfma_f32_16x16x32_bf16 v[40:43], v[208:211], v[116:119], v[40:43]
    ds_read_b64_tr_b16 v[228:229], v165 offset:12288
    v_mfma_f32_16x16x32_bf16 v[44:47], v[212:215], v[116:119], v[44:47]
    ds_read_b64_tr_b16 v[230:231], v165 offset:12800
    v_mfma_f32_16x16x32_bf16 v[48:51], v[200:203], v[120:123], v[48:51]
    v_mfma_f32_16x16x32_bf16 v[52:55], v[204:207], v[120:123], v[52:55]
    v_mfma_f32_16x16x32_bf16 v[56:59], v[208:211], v[120:123], v[56:59]
    v_mfma_f32_16x16x32_bf16 v[60:63], v[212:215], v[120:123], v[60:63]
    v_mfma_f32_16x16x32_bf16 v[64:67], v[200:203], v[124:127], v[64:67]
    v_mfma_f32_16x16x32_bf16 v[68:71], v[204:207], v[124:127], v[68:71]
    v_mfma_f32_16x16x32_bf16 v[72:75], v[208:211], v[124:127], v[72:75]
    v_mfma_f32_16x16x32_bf16 v[76:79], v[212:215], v[124:127], v[76:79]
    s_add_u32 m0, s42, 4096
    s_add_u32 s40, s39, 0
    buffer_load_dwordx4 v8, s[44:47], s40 offen lds
    s_add_u32 m0, s42, 5120
    s_add_u32 s40, s39, 8192
    buffer_load_dwordx4 v9, s[44:47], s40 offen lds
    s_add_u32 m0, s42, 6144
    s_add_u32 s40, s39, 16384
    buffer_load_dwordx4 v8, s[44:47], s40 offen lds
    s_add_u32 m0, s42, 7168
    s_add_u32 s40, s39, 24576
    buffer_load_dwordx4 v9, s[44:47], s40 offen lds
    s_add_u32 s39, s39, 131072
    buffer_load_dwordx4 v[96:99], v4, s[24:27], s38 offen sc1
    buffer_load_dwordx4 v[100:103], v5, s[24:27], s38 offen sc1
    buffer_load_dwordx4 v[104:107], v6, s[24:27], s38 offen sc1
    buffer_load_dwordx4 v[108:111], v7, s[24:27], s38 offen sc1
    s_add_u32 s38, s38, 16384
    s_waitcnt vmcnt(12) lgkmcnt(0)
    v_mfma_f32_16x16x32_bf16 v[16:19], v[216:219], v[128:131], v[16:19]
    ds_read_b64_tr_b16 v[200:201], v162 offset:0
    v_mfma_f32_16x16x32_bf16 v[20:23], v[220:223], v[128:131], v[20:23]
    ds_read_b64_tr_b16 v[202:203], v162 offset:512
    v_mfma_f32_16x16x32_bf16 v[24:27], v[224:227], v[128:131], v[24:27]
    ds_read_b64_tr_b16 v[204:205], v163 offset:0
    v_mfma_f32_16x16x32_bf16 v[28:31], v[228:231], v[128:131], v[28:31]
    ds_read_b64_tr_b16 v[206:207], v163 offset:512
    v_mfma_f32_16x16x32_bf16 v[32:35], v[216:219], v[132:135], v[32:35]
    ds_read_b64_tr_b16 v[208:209], v164 offset:0
    v_mfma_f32_16x16x32_bf16 v[36:39], v[220:223], v[132:135], v[36:39]
    ds_read_b64_tr_b16 v[210:211], v164 offset:512
    v_mfma_f32_16x16x32_bf16 v[40:43], v[224:227], v[132:135], v[40:43]
    ds_read_b64_tr_b16 v[212:213], v165 offset:0
    v_mfma_f32_16x16x32_bf16 v[44:47], v[228:231], v[132:135], v[44:47]
    ds_read_b64_tr_b16 v[214:215], v165 offset:512
    v_mfma_f32_16x16x32_bf16 v[48:51], v[216:219], v[136:139], v[48:51]
    v_mfma_f32_16x16x32_bf16 v[52:55], v[220:223], v[136:139], v[52:55]
    v_mfma_f32_16x16x32_bf16 v[56:59], v[224:227], v[136:139], v[56:59]
    v_mfma_f32_16x16x32_bf16 v[60:63], v[228:231], v[136:139], v[60:63]
    v_mfma_f32_16x16x32_bf16 v[64:67], v[216:219], v[140:143], v[64:67]
    v_mfma_f32_16x16x32_bf16 v[68:71], v[220:223], v[140:143], v[68:71]
    v_mfma_f32_16x16x32_bf16 v[72:75], v[224:227], v[140:143], v[72:75]
    v_mfma_f32_16x16x32_bf16 v[76:79], v[228:231], v[140:143], v[76:79]
    s_add_u32 m0, s42, 8192
    s_add_u32 s40, s39, 0
    buffer_load_dwordx4 v8, s[44:47], s40 offen lds
    s_add_u32 m0, s42, 9216
    s_add_u32 s40, s39, 8192
    buffer_load_dwordx4 v9, s[44:47], s40 offen lds
    s_add_u32 m0, s42, 10240
    s_add_u32 s40, s39, 16384
    buffer_load_dwordx4 v8, s[44:47], s40 offen lds
    s_add_u32 m0, s42, 11264
    s_add_u32 s40, s39, 24576
    buffer_load_dwordx4 v9, s[44:47], s40 offen lds
    s_add_u32 s39, s39, 131072
    buffer_load_dwordx4 v[112:115], v4, s[24:27], s38 offen sc1
    buffer_load_dwordx4 v[116:119], v5, s[24:27], s38 offen sc1
    buffer_load_dwordx4 v[120:123], v6, s[24:27], s38 offen sc1
    buffer_load_dwordx4 v[124:127], v7, s[24:27], s38 offen sc1
    s_add_u32 s38, s38, 16384
    s_waitcnt vmcnt(12) lgkmcnt(0)
    v_mfma_f32_16x16x32_bf16 v[16:19], v[200:203], v[80:83], v[16:19]
    ds_read_b64_tr_b16 v[216:217], v162 offset:4096
    v_mfma_f32_16x16x32_bf16 v[20:23], v[204:207], v[80:83], v[20:23]
    ds_read_b64_tr_b16 v[218:219], v162 offset:4608
    v_mfma_f32_16x16x32_bf16 v[24:27], v[208:211], v[80:83], v[24:27]
    ds_read_b64_tr_b16 v[220:221], v163 offset:4096
    v_mfma_f32_16x16x32_bf16 v[28:31], v[212:215], v[80:83], v[28:31]
    ds_read_b64_tr_b16 v[222:223], v163 offset:4608
    v_mfma_f32_16x16x32_bf16 v[32:35], v[200:203], v[84:87], v[32:35]
    ds_read_b64_tr_b16 v[224:225], v164 offset:4096
    v_mfma_f32_16x16x32_bf16 v[36:39], v[204:207], v[84:87], v[36:39]
    ds_read_b64_tr_b16 v[226:227], v164 offset:4608
    v_mfma_f32_16x16x32_bf16 v[40:43], v[208:211], v[84:87], v[40:43]
    ds_read_b64_tr_b16 v[228:229], v165 offset:4096
    v_mfma_f32_16x16x32_bf16 v[44:47], v[212:215], v[84:87], v[44:47]
    ds_read_b64_tr_b16 v[230:231], v165 offset:4608
    v_mfma_f32_16x16x32_bf16 v[48:51], v[200:203], v[88:91], v[48:51]
    v_mfma_f32_16x16x32_bf16 v[52:55], v[204:207], v[88:91], v[52:55]
    v_mfma_f32_16x16x32_bf16 v[56:59], v[208:211], v[88:91], v[56:59]
    v_mfma_f32_16x16x32_bf16 v[60:63], v[212:215], v[88:91], v[60:63]
    v_mfma_f32_16x16x32_bf16 v[64:67], v[200:203], v[92:95], v[64:67]
    v_mfma_f32_16x16x32_bf16 v[68:71], v[204:207], v[92:95], v[68:71]
    v_mfma_f32_16x16x32_bf16 v[72:75], v[208:211], v[92:95], v[72:75]
    v_mfma_f32_16x16x32_bf16 v[76:79], v[212:215], v[92:95], v[76:79]
    s_add_u32 m0, s42, 12288
    s_add_u32 s40, s39, 0
    buffer_load_dwordx4 v8, s[44:47], s40 offen lds
    s_add_u32 m0, s42, 13312
    s_add_u32 s40, s39, 8192
    buffer_load_dwordx4 v9, s[44:47], s40 offen lds
    s_add_u32 m0, s42, 14336
    s_add_u32 s40, s39, 16384
    buffer_load_dwordx4 v8, s[44:47], s40 offen lds
    s_add_u32 m0, s42, 15360
    s_add_u32 s40, s39, 24576
    buffer_load_dwordx4 v9, s[44:47], s40 offen lds
    s_add_u32 s39, s39, 131072
    buffer_load_dwordx4 v[128:131], v4, s[24:27], s38 offen sc1
    buffer_load_dwordx4 v[132:135], v5, s[24:27], s38 offen sc1
    buffer_load_dwordx4 v[136:139], v6, s[24:27], s38 offen sc1
    buffer_load_dwordx4 v[140:143], v7, s[24:27], s38 offen sc1
    s_add_u32 s38, s38, 16384
    s_waitcnt vmcnt(12) lgkmcnt(0)
    v_mfma_f32_16x16x32_bf16 v[16:19], v[216:219], v[96:99], v[16:19]
    ds_read_b64_tr_b16 v[200:201], v162 offset:8192
    v_mfma_f32_16x16x32_bf16 v[20:23], v[220:223], v[96:99], v[20:23]
    ds_read_b64_tr_b16 v[202:203], v162 offset:8704
    v_mfma_f32_16x16x32_bf16 v[24:27], v[224:227], v[96:99], v[24:27]
    ds_read_b64_tr_b16 v[204:205], v163 offset:8192
    v_mfma_f32_16x16x32_bf16 v[28:31], v[228:231], v[96:99], v[28:31]
    ds_read_b64_tr_b16 v[206:207], v163 offset:8704
    v_mfma_f32_16x16x32_bf16 v[32:35], v[216:219], v[100:103], v[32:35]
    ds_read_b64_tr_b16 v[208:209], v164 offset:8192
    v_mfma_f32_16x16x32_bf16 v[36:39], v[220:223], v[100:103], v[36:39]
    ds_read_b64_tr_b16 v[210:211], v164 offset:8704
    v_mfma_f32_16x16x32_bf16 v[40:43], v[224:227], v[100:103], v[40:43]
    ds_read_b64_tr_b16 v[212:213], v165 offset:8192
    v_mfma_f32_16x16x32_bf16 v[44:47], v[228:231], v[100:103], v[44:47]
    ds_read_b64_tr_b16 v[214:215], v165 offset:8704
    v_mfma_f32_16x16x32_bf16 v[48:51], v[216:219], v[104:107], v[48:51]
    v_mfma_f32_16x16x32_bf16 v[52:55], v[220:223], v[104:107], v[52:55]
    v_mfma_f32_16x16x32_bf16 v[56:59], v[224:227], v[104:107], v[56:59]
    v_mfma_f32_16x16x32_bf16 v[60:63], v[228:231], v[104:107], v[60:63]
    v_mfma_f32_16x16x32_bf16 v[64:67], v[216:219], v[108:111], v[64:67]
    v_mfma_f32_16x16x32_bf16 v[68:71], v[220:223], v[108:111], v[68:71]
    v_mfma_f32_16x16x32_bf16 v[72:75], v[224:227], v[108:111], v[72:75]
    v_mfma_f32_16x16x32_bf16 v[76:79], v[228:231], v[108:111], v[76:79]
    s_add_u32 m0, s42, 0
    s_add_u32 s40, s39, 0
    buffer_load_dwordx4 v8, s[44:47], s40 offen lds
    s_add_u32 m0, s42, 1024
    s_add_u32 s40, s39, 8192
    buffer_load_dwordx4 v9, s[44:47], s40 offen lds
    s_add_u32 m0, s42, 2048
    s_add_u32 s40, s39, 16384
    buffer_load_dwordx4 v8, s[44:47], s40 offen lds
    s_add_u32 m0, s42, 3072
    s_add_u32 s40, s39, 24576
    buffer_load_dwordx4 v9, s[44:47], s40 offen lds
    s_add_u32 s39, s39, 131072
    buffer_load_dwordx4 v[80:83], v4, s[24:27], s38 offen sc1
    buffer_load_dwordx4 v[84:87], v5, s[24:27], s38 offen sc1
    buffer_load_dwordx4 v[88:91], v6, s[24:27], s38 offen sc1
    buffer_load_dwordx4 v[92:95], v7, s[24:27], s38 offen sc1
    s_add_u32 s38, s38, 16384
    s_waitcnt vmcnt(12) lgkmcnt(0)
    v_mfma_f32_16x16x32_bf16 v[16:19], v[200:203], v[112:115], v[16:19]
    ds_read_b64_tr_b16 v[216:217], v162 offset:12288
    v_mfma_f32_16x16x32_bf16 v[20:23], v[204:207], v[112:115], v[20:23]
    ds_read_b64_tr_b16 v[218:219], v162 offset:12800
    v_mfma_f32_16x16x32_bf16 v[24:27], v[208:211], v[112:115], v[24:27]
    ds_read_b64_tr_b16 v[220:221], v163 offset:12288
    v_mfma_f32_16x16x32_bf16 v[28:31], v[212:215], v[112:115], v[28:31]
    ds_read_b64_tr_b16 v[222:223], v163 offset:12800
    v_mfma_f32_16x16x32_bf16 v[32:35], v[200:203], v[116:119], v[32:35]
    ds_read_b64_tr_b16 v[224:225], v164 offset:12288
    v_mfma_f32_16x16x32_bf16 v[36:39], v[204:207], v[116:119], v[36:39]
    ds_read_b64_tr_b16 v[226:227], v164 offset:12800
    v_mfma_f32_16x16x32_bf16 v[40:43], v[208:211], v[116:119], v[40:43]
    ds_read_b64_tr_b16 v[228:229], v165 offset:12288
    v_mfma_f32_16x16x32_bf16 v[44:47], v[212:215], v[116:119], v[44:47]
    ds_read_b64_tr_b16 v[230:231], v165 offset:12800
    v_mfma_f32_16x16x32_bf16 v[48:51], v[200:203], v[120:123], v[48:51]
    v_mfma_f32_16x16x32_bf16 v[52:55], v[204:207], v[120:123], v[52:55]
    v_mfma_f32_16x16x32_bf16 v[56:59], v[208:211], v[120:123], v[56:59]
    v_mfma_f32_16x16x32_bf16 v[60:63], v[212:215], v[120:123], v[60:63]
    v_mfma_f32_16x16x32_bf16 v[64:67], v[200:203], v[124:127], v[64:67]
    v_mfma_f32_16x16x32_bf16 v[68:71], v[204:207], v[124:127], v[68:71]
    v_mfma_f32_16x16x32_bf16 v[72:75], v[208:211], v[124:127], v[72:75]
    v_mfma_f32_16x16x32_bf16 v[76:79], v[212:215], v[124:127], v[76:79]
    s_add_u32 m0, s42, 4096
    s_add_u32 s40, s39, 0
    buffer_load_dwordx4 v8, s[44:47], s40 offen lds
    s_add_u32 m0, s42, 5120
    s_add_u32 s40, s39, 8192
    buffer_load_dwordx4 v9, s[44:47], s40 offen lds
    s_add_u32 m0, s42, 6144
    s_add_u32 s40, s39, 16384
    buffer_load_dwordx4 v8, s[44:47], s40 offen lds
    s_add_u32 m0, s42, 7168
    s_add_u32 s40, s39, 24576
    buffer_load_dwordx4 v9, s[44:47], s40 offen lds
    s_add_u32 s39, s39, 131072
    buffer_load_dwordx4 v[96:99], v4, s[24:27], s38 offen sc1
    buffer_load_dwordx4 v[100:103], v5, s[24:27], s38 offen sc1
    buffer_load_dwordx4 v[104:107], v6, s[24:27], s38 offen sc1
    buffer_load_dwordx4 v[108:111], v7, s[24:27], s38 offen sc1
    s_add_u32 s38, s38, 16384
    s_waitcnt vmcnt(12) lgkmcnt(0)
    v_mfma_f32_16x16x32_bf16 v[16:19], v[216:219], v[128:131], v[16:19]
    ds_read_b64_tr_b16 v[200:201], v162 offset:0
    v_mfma_f32_16x16x32_bf16 v[20:23], v[220:223], v[128:131], v[20:23]
    ds_read_b64_tr_b16 v[202:203], v162 offset:512
    v_mfma_f32_16x16x32_bf16 v[24:27], v[224:227], v[128:131], v[24:27]
    ds_read_b64_tr_b16 v[204:205], v163 offset:0
    v_mfma_f32_16x16x32_bf16 v[28:31], v[228:231], v[128:131], v[28:31]
    ds_read_b64_tr_b16 v[206:207], v163 offset:512
    v_mfma_f32_16x16x32_bf16 v[32:35], v[216:219], v[132:135], v[32:35]
    ds_read_b64_tr_b16 v[208:209], v164 offset:0
    v_mfma_f32_16x16x32_bf16 v[36:39], v[220:223], v[132:135], v[36:39]
    ds_read_b64_tr_b16 v[210:211], v164 offset:512
    v_mfma_f32_16x16x32_bf16 v[40:43], v[224:227], v[132:135], v[40:43]
    ds_read_b64_tr_b16 v[212:213], v165 offset:0
    v_mfma_f32_16x16x32_bf16 v[44:47], v[228:231], v[132:135], v[44:47]
    ds_read_b64_tr_b16 v[214:215], v165 offset:512
    v_mfma_f32_16x16x32_bf16 v[48:51], v[216:219], v[136:139], v[48:51]
    v_mfma_f32_16x16x32_bf16 v[52:55], v[220:223], v[136:139], v[52:55]
    v_mfma_f32_16x16x32_bf16 v[56:59], v[224:227], v[136:139], v[56:59]
    v_mfma_f32_16x16x32_bf16 v[60:63], v[228:231], v[136:139], v[60:63]
    v_mfma_f32_16x16x32_bf16 v[64:67], v[216:219], v[140:143], v[64:67]
    v_mfma_f32_16x16x32_bf16 v[68:71], v[220:223], v[140:143], v[68:71]
    v_mfma_f32_16x16x32_bf16 v[72:75], v[224:227], v[140:143], v[72:75]
    v_mfma_f32_16x16x32_bf16 v[76:79], v[228:231], v[140:143], v[76:79]
    s_cmp_eq_u32 s28, 3
    s_cselect_b32 s39, 0x7ff00000, s39
    s_add_u32 m0, s42, 8192
    s_add_u32 s40, s39, 0
    buffer_load_dwordx4 v8, s[44:47], s40 offen lds
    s_add_u32 m0, s42, 9216
    s_add_u32 s40, s39, 8192
    buffer_load_dwordx4 v9, s[44:47], s40 offen lds
    s_add_u32 m0, s42, 10240
    s_add_u32 s40, s39, 16384
    buffer_load_dwordx4 v8, s[44:47], s40 offen lds
    s_add_u32 m0, s42, 11264
    s_add_u32 s40, s39, 24576
    buffer_load_dwordx4 v9, s[44:47], s40 offen lds
    s_add_u32 s39, s39, 131072
    s_cmp_eq_u32 s28, 3
    s_cselect_b32 s38, 0x7ff00000, s38
    buffer_load_dwordx4 v[112:115], v4, s[24:27], s38 offen sc1
    buffer_load_dwordx4 v[116:119], v5, s[24:27], s38 offen sc1
    buffer_load_dwordx4 v[120:123], v6, s[24:27], s38 offen sc1
    buffer_load_dwordx4 v[124:127], v7, s[24:27], s38 offen sc1
    s_add_u32 s38, s38, 16384
    s_mov_b32 exec_lo, -1
    s_mov_b32 exec_hi, 0
    buffer_load_dword v194, v193, s[24:27], s52 offen sc1
    s_mov_b64 exec, -1
    s_mov_b32 s55, 0
    s_waitcnt vmcnt(13) lgkmcnt(0)
    v_mfma_f32_16x16x32_bf16 v[16:19], v[200:203], v[80:83], v[16:19]
    ds_read_b64_tr_b16 v[216:217], v162 offset:4096
    v_mfma_f32_16x16x32_bf16 v[20:23], v[204:207], v[80:83], v[20:23]
    ds_read_b64_tr_b16 v[218:219], v162 offset:4608
    v_mfma_f32_16x16x32_bf16 v[24:27], v[208:211], v[80:83], v[24:27]
    ds_read_b64_tr_b16 v[220:221], v163 offset:4096
    v_mfma_f32_16x16x32_bf16 v[28:31], v[212:215], v[80:83], v[28:31]
    ds_read_b64_tr_b16 v[222:223], v163 offset:4608
    v_mfma_f32_16x16x32_bf16 v[32:35], v[200:203], v[84:87], v[32:35]
    ds_read_b64_tr_b16 v[224:225], v164 offset:4096
    v_mfma_f32_16x16x32_bf16 v[36:39], v[204:207], v[84:87], v[36:39]
    ds_read_b64_tr_b16 v[226:227], v164 offset:4608
    v_mfma_f32_16x16x32_bf16 v[40:43], v[208:211], v[84:87], v[40:43]
    ds_read_b64_tr_b16 v[228:229], v165 offset:4096
    v_mfma_f32_16x16x32_bf16 v[44:47], v[212:215], v[84:87], v[44:47]
    ds_read_b64_tr_b16 v[230:231], v165 offset:4608
    v_mfma_f32_16x16x32_bf16 v[48:51], v[200:203], v[88:91], v[48:51]
    v_mfma_f32_16x16x32_bf16 v[52:55], v[204:207], v[88:91], v[52:55]
    v_mfma_f32_16x16x32_bf16 v[56:59], v[208:211], v[88:91], v[56:59]
    v_mfma_f32_16x16x32_bf16 v[60:63], v[212:215], v[88:91], v[60:63]
    v_mfma_f32_16x16x32_bf16 v[64:67], v[200:203], v[92:95], v[64:67]
    v_mfma_f32_16x16x32_bf16 v[68:71], v[204:207], v[92:95], v[68:71]
    v_mfma_f32_16x16x32_bf16 v[72:75], v[208:211], v[92:95], v[72:75]
    v_mfma_f32_16x16x32_bf16 v[76:79], v[212:215], v[92:95], v[76:79]
    s_waitcnt vmcnt(5) lgkmcnt(0)
    v_mfma_f32_16x16x32_bf16 v[16:19], v[216:219], v[96:99], v[16:19]
    ds_read_b64_tr_b16 v[200:201], v162 offset:8192
    v_mfma_f32_16x16x32_bf16 v[20:23], v[220:223], v[96:99], v[20:23]
    ds_read_b64_tr_b16 v[202:203], v162 offset:8704
    v_mfma_f32_16x16x32_bf16 v[24:27], v[224:227], v[96:99], v[24:27]
    ds_read_b64_tr_b16 v[204:205], v163 offset:8192
    v_mfma_f32_16x16x32_bf16 v[28:31], v[228:231], v[96:99], v[28:31]
    ds_read_b64_tr_b16 v[206:207], v163 offset:8704
    v_mfma_f32_16x16x32_bf16 v[32:35], v[216:219], v[100:103], v[32:35]
    ds_read_b64_tr_b16 v[208:209], v164 offset:8192
    v_mfma_f32_16x16x32_bf16 v[36:39], v[220:223], v[100:103], v[36:39]
    ds_read_b64_tr_b16 v[210:211], v164 offset:8704
    v_mfma_f32_16x16x32_bf16 v[40:43], v[224:227], v[100:103], v[40:43]
    ds_read_b64_tr_b16 v[212:213], v165 offset:8192
    v_mfma_f32_16x16x32_bf16 v[44:47], v[228:231], v[100:103], v[44:47]
    ds_read_b64_tr_b16 v[214:215], v165 offset:8704
    v_mfma_f32_16x16x32_bf16 v[48:51], v[216:219], v[104:107], v[48:51]
    v_mfma_f32_16x16x32_bf16 v[52:55], v[220:223], v[104:107], v[52:55]
    v_mfma_f32_16x16x32_bf16 v[56:59], v[224:227], v[104:107], v[56:59]
    v_mfma_f32_16x16x32_bf16 v[60:63], v[228:231], v[104:107], v[60:63]
    v_mfma_f32_16x16x32_bf16 v[64:67], v[216:219], v[108:111], v[64:67]
    v_mfma_f32_16x16x32_bf16 v[68:71], v[220:223], v[108:111], v[68:71]
    v_mfma_f32_16x16x32_bf16 v[72:75], v[224:227], v[108:111], v[72:75]
    v_mfma_f32_16x16x32_bf16 v[76:79], v[228:231], v[108:111], v[76:79]
    s_waitcnt vmcnt(0)
    v_cmp_ne_u32 vcc, s59, v194
    s_cmp_eq_u32 vcc_lo, 0
    s_cbranch_scc0 g_yearly
    s_mov_b32 s55, 1
    buffer_load_dwordx4 v[184:187], v183, s[24:27], s50 offen sc1
    buffer_load_dwordx4 v[188:191], v183, s[24:27], s51 offen sc1
g_yearly:
    s_waitcnt vmcnt(1) lgkmcnt(0)
    v_mfma_f32_16x16x32_bf16 v[16:19], v[200:203], v[112:115], v[16:19]
    v_mfma_f32_16x16x32_bf16 v[20:23], v[204:207], v[112:115], v[20:23]
    v_mfma_f32_16x16x32_bf16 v[24:27], v[208:211], v[112:115], v[24:27]
    v_mfma_f32_16x16x32_bf16 v[28:31], v[212:215], v[112:115], v[28:31]
    v_mfma_f32_16x16x32_bf16 v[32:35], v[200:203], v[116:119], v[32:35]
    v_mfma_f32_16x16x32_bf16 v[36:39], v[204:207], v[116:119], v[36:39]
    v_mfma_f32_16x16x32_bf16 v[40:43], v[208:211], v[116:119], v[40:43]
    v_mfma_f32_16x16x32_bf16 v[44:47], v[212:215], v[116:119], v[44:47]
    v_mfma_f32_16x16x32_bf16 v[48:51], v[200:203], v[120:123], v[48:51]
    v_mfma_f32_16x16x32_bf16 v[52:55], v[204:207], v[120:123], v[52:55]
    v_mfma_f32_16x16x32_bf16 v[56:59], v[208:211], v[120:123], v[56:59]
    v_mfma_f32_16x16x32_bf16 v[60:63], v[212:215], v[120:123], v[60:63]
    v_mfma_f32_16x16x32_bf16 v[64:67], v[200:203], v[124:127], v[64:67]
    v_mfma_f32_16x16x32_bf16 v[68:71], v[204:207], v[124:127], v[68:71]
    v_mfma_f32_16x16x32_bf16 v[72:75], v[208:211], v[124:127], v[72:75]
    v_mfma_f32_16x16x32_bf16 v[76:79], v[212:215], v[124:127], v[76:79]
    s_nop 4
    s_barrier
    v_lshlrev_b32 v2, 4, v1
    s_mul_i32 s37, s28, 12288
    v_add_u32 v3, s37, v2
    ds_write_b128 v3, v[32:35] offset:0
    ds_write_b128 v3, v[36:39] offset:1024
    ds_write_b128 v3, v[40:43] offset:2048
    ds_write_b128 v3, v[44:47] offset:3072
    ds_write_b128 v3, v[48:51] offset:4096
    ds_write_b128 v3, v[52:55] offset:5120
    ds_write_b128 v3, v[56:59] offset:6144
    ds_write_b128 v3, v[60:63] offset:7168
    ds_write_b128 v3, v[64:67] offset:8192
    ds_write_b128 v3, v[68:71] offset:9216
    ds_write_b128 v3, v[72:75] offset:10240
    ds_write_b128 v3, v[76:79] offset:11264
    s_cmp_eq_u32 s55, 1
    s_cbranch_scc1 g_yhave
    s_mov_b32 s98, 0
g_yf:
    s_mov_b32 exec_lo, 0xffffffff
    s_mov_b32 exec_hi, 0x0
    buffer_load_dword v194, v193, s[24:27], s52 offen sc1
    s_mov_b64 exec, -1
    s_waitcnt vmcnt(0)
    v_cmp_ne_u32 vcc, s59, v194
    s_mov_b32 s96, 0xffffffff
    s_mov_b32 s97, 0x0
    s_and_b64 vcc, vcc, s[96:97]
    s_cmp_eq_u64 vcc, 0
    s_cbranch_scc1 g_yfok
    s_add_u32 s98, s98, 1
    s_cmp_gt_u32 s98, 20000
    s_cbranch_scc1 g_yfok
    s_sleep 1
    s_branch g_yf
g_yfok:
    buffer_load_dwordx4 v[184:187], v183, s[24:27], s50 offen sc1
    buffer_load_dwordx4 v[188:191], v183, s[24:27], s51 offen sc1
g_yhave:
    s_waitcnt vmcnt(0)
    ds_write_b128 v180, v[184:187]
    ds_write_b128 v180, v[188:191] offset:4096
    s_waitcnt lgkmcnt(0)
    s_barrier
    s_sub_u32 s37, s28, 1
    s_and_b32 s37, s37, 3
    s_mul_i32 s37, s37, 12288
    v_add_u32 v3, s37, v2
    ds_read_b128 v[80:83], v3 offset:0
    ds_read_b128 v[84:87], v3 offset:1024
    ds_read_b128 v[88:91], v3 offset:2048
    ds_read_b128 v[92:95], v3 offset:3072
    s_sub_u32 s37, s28, 2
    s_and_b32 s37, s37, 3
    s_mul_i32 s37, s37, 12288
    v_add_u32 v3, s37, v2
    ds_read_b128 v[96:99], v3 offset:4096
    ds_read_b128 v[100:103], v3 offset:5120
    ds_read_b128 v[104:107], v3 offset:6144
    ds_read_b128 v[108:111], v3 offset:7168
    s_sub_u32 s37, s28, 3
    s_and_b32 s37, s37, 3
    s_mul_i32 s37, s37, 12288
    v_add_u32 v3, s37, v2
    ds_read_b128 v[112:115], v3 offset:8192
    ds_read_b128 v[116:119], v3 offset:9216
    ds_read_b128 v[120:123], v3 offset:10240
    ds_read_b128 v[124:127], v3 offset:11264
    v_lshrrev_b32 v12, 4, v1
    v_bfe_u32 v4, v1, 2, 2
    v_lshl_add_u32 v4, v12, 2, v4
    v_lshlrev_b32 v4, 7, v4
    v_and_b32 v5, 3, v1
    v_lshl_add_u32 v4, v5, 3, v4
    s_lshl_b32 s37, s28, 5
    s_add_u32 s37, s37, 66560
    v_add_u32 v4, s37, v4
    ds_read_b64_tr_b16 v[128:129], v4 offset:0
    ds_read_b64_tr_b16 v[130:131], v4 offset:2048
    ds_read_b64_tr_b16 v[132:133], v4 offset:4096
    ds_read_b64_tr_b16 v[134:135], v4 offset:6144
    v_and_b32 v5, 15, v1
    v_mul_u32_u24 v5, 272, v5
    v_lshl_add_u32 v5, v12, 4, v5
    s_mul_i32 s37, s28, 4352
    s_add_u32 s37, s37, 49152
    v_add_u32 v5, s37, v5
    v_lshrrev_b32 v6, 3, v1
    v_mul_u32_u24 v6, 272, v6
    v_and_b32 v7, 7, v1
    v_lshl_add_u32 v6, v7, 5, v6
    v_add_u32 v6, s37, v6
    s_waitcnt lgkmcnt(0)
    v_pk_add_f32 v[80:81], v[80:81], v[96:97]
    v_pk_add_f32 v[16:17], v[16:17], v[112:113]
    v_pk_add_f32 v[82:83], v[82:83], v[98:99]
    v_pk_add_f32 v[18:19], v[18:19], v[114:115]
    v_pk_add_f32 v[84:85], v[84:85], v[100:101]
    v_pk_add_f32 v[20:21], v[20:21], v[116:117]
    v_pk_add_f32 v[86:87], v[86:87], v[102:103]
    v_pk_add_f32 v[22:23], v[22:23], v[118:119]
    v_pk_add_f32 v[88:89], v[88:89], v[104:105]
    v_pk_add_f32 v[24:25], v[24:25], v[120:121]
    v_pk_add_f32 v[90:91], v[90:91], v[106:107]
    v_pk_add_f32 v[26:27], v[26:27], v[122:123]
    v_pk_add_f32 v[92:93], v[92:93], v[108:109]
    v_pk_add_f32 v[28:29], v[28:29], v[124:125]
    v_pk_add_f32 v[94:95], v[94:95], v[110:111]
    v_pk_add_f32 v[30:31], v[30:31], v[126:127]
    v_lshlrev_b32 v96, 16, v128
    v_and_b32 v97, 0xffff0000, v128
    v_lshlrev_b32 v98, 16, v129
    v_and_b32 v99, 0xffff0000, v129
    v_lshlrev_b32 v100, 16, v130
    v_and_b32 v101, 0xffff0000, v130
    v_lshlrev_b32 v102, 16, v131
    v_and_b32 v103, 0xffff0000, v131
    v_lshlrev_b32 v104, 16, v132
    v_and_b32 v105, 0xffff0000, v132
    v_lshlrev_b32 v106, 16, v133
    v_and_b32 v107, 0xffff0000, v133
    v_lshlrev_b32 v108, 16, v134
    v_and_b32 v109, 0xffff0000, v134
    v_lshlrev_b32 v110, 16, v135
    v_and_b32 v111, 0xffff0000, v135
    v_pk_add_f32 v[16:17], v[16:17], v[80:81]
    v_pk_add_f32 v[18:19], v[18:19], v[82:83]
    v_pk_add_f32 v[20:21], v[20:21], v[84:85]
    v_pk_add_f32 v[22:23], v[22:23], v[86:87]
    v_pk_add_f32 v[24:25], v[24:25], v[88:89]
    v_pk_add_f32 v[26:27], v[26:27], v[90:91]
    v_pk_add_f32 v[28:29], v[28:29], v[92:93]
    v_pk_add_f32 v[30:31], v[30:31], v[94:95]
    v_pk_add_f32 v[16:17], v[16:17], v[96:97]
    v_pk_add_f32 v[18:19], v[18:19], v[98:99]
    v_pk_add_f32 v[20:21], v[20:21], v[100:101]
    v_pk_add_f32 v[22:23], v[22:23], v[102:103]
    v_pk_add_f32 v[24:25], v[24:25], v[104:105]
    v_pk_add_f32 v[26:27], v[26:27], v[106:107]
    v_pk_add_f32 v[28:29], v[28:29], v[108:109]
    v_pk_add_f32 v[30:31], v[30:31], v[110:111]
    ds_write_b128 v5, v[16:19] offset:0
    ds_write_b128 v5, v[20:23] offset:64
    ds_write_b128 v5, v[24:27] offset:128
    ds_write_b128 v5, v[28:31] offset:192
    s_waitcnt lgkmcnt(0)
    ds_read_b128 v[64:67], v6 offset:0
    ds_read_b128 v[68:71], v6 offset:16
    ds_read_b128 v[72:75], v6 offset:2176
    ds_read_b128 v[76:79], v6 offset:2192
    s_waitcnt lgkmcnt(0)
    v_pk_add_f32 v[64:65], v[64:65], v[232:233]
    v_pk_add_f32 v[66:67], v[66:67], v[234:235]
    v_pk_add_f32 v[68:69], v[68:69], v[236:237]
    v_pk_add_f32 v[70:71], v[70:71], v[238:239]
    v_cvt_pk_bf16_f32 v80, v64, v65
    v_cvt_pk_bf16_f32 v81, v66, v67
    v_cvt_pk_bf16_f32 v82, v68, v69
    v_cvt_pk_bf16_f32 v83, v70, v71
    v_pk_add_f32 v[72:73], v[72:73], v[240:241]
    v_pk_add_f32 v[74:75], v[74:75], v[242:243]
    v_pk_add_f32 v[76:77], v[76:77], v[244:245]
    v_pk_add_f32 v[78:79], v[78:79], v[246:247]
    v_cvt_pk_bf16_f32 v84, v72, v73
    v_cvt_pk_bf16_f32 v85, v74, v75
    v_cvt_pk_bf16_f32 v86, v76, v77
    v_cvt_pk_bf16_f32 v87, v78, v79
    s_movk_i32 s40, 0x2000
    buffer_store_dwordx4 v[80:83], v166, s[20:23], 0 offen
    buffer_store_dwordx4 v[84:87], v166, s[20:23], s40 offen
g_end:
k_end:
    s_endpgm
code_end:
.section .rodata,"a"
.p2align 6
.amdhsa_kernel parallel_sum__ssm_conv_s4d__mixer_channel_mlp__prompt_kernel
  .amdhsa_next_free_vgpr 256
  .amdhsa_next_free_sgpr 100
  .amdhsa_accum_offset 256
  .amdhsa_group_segment_fixed_size 0
  .amdhsa_kernarg_size 120
  .amdhsa_user_sgpr_count 2
  .amdhsa_user_sgpr_kernarg_segment_ptr 1
  .amdhsa_system_sgpr_workgroup_id_x 1
  .amdhsa_float_denorm_mode_32 3
  .amdhsa_float_denorm_mode_16_64 3
.end_amdhsa_kernel
```
